```python
import torch

def _softmax(x, axis=-1):
    return torch.softmax(x, dim=axis)
def _gelu(x):
    return torch.nn.functional.gelu(x, approximate="tanh")
def _silu(x):
    return torch.nn.functional.silu(x)
def _sigmoid(x):
    return torch.sigmoid(x)
def _layernorm(x, axis=-1, eps=1e-5):
    m = x.mean(dim=axis, keepdim=True)
    v = x.var(dim=axis, keepdim=True, unbiased=False)
    return (x - m) / torch.sqrt(v + eps)
def _scatter_add(tgt, idx, src, axis=0):
    return tgt.clone().index_add_(axis, idx, src)
def _segment_sum(src, seg, n):
    out = torch.zeros((n,) + src.shape[1:], dtype=src.dtype)
    return out.index_add_(0, seg, src)
def _pad(x, pw):
    flat = tuple(v for pair in reversed(pw) for v in pair)
    return torch.nn.functional.pad(x, flat)

kernel_name = 'standalone__sliding_block_cached__sampling'

def setup_inputs():

    _w = (lambda a: (lambda t: t.to(torch.bfloat16) if t.is_floating_point() else t)(torch.as_tensor(a)))
    B, Sq, D = 16, 4, 512
    Hq, Hkv, Sk, Dh = 32, 8, 4096, 128
    assert Hq % Hkv == 0, (Hq, Hkv)
    return {
        "x": _w((lambda *s: torch.randn(*s, dtype=torch.bfloat16) * 0.8)(B, Sq, D)),
        "k_cache": _w((lambda *s: torch.randn(*s, dtype=torch.bfloat16) * 0.8)(B, Hkv, Sk, Dh)),
        "v_cache": _w((lambda *s: torch.randn(*s, dtype=torch.bfloat16) * 0.05)(B, Hkv, Sk, Dh)),
        "wq": _w((lambda *s: torch.randn(*s, dtype=torch.bfloat16) * 0.8)(D, Hq * Dh) * (D ** -0.5)),
        "wo": _w((lambda *s: torch.randn(*s, dtype=torch.bfloat16) * 0.05)(Hq * Dh, D) * ((Hq * Dh) ** -0.5)),
    }

def reference(x, k_cache, v_cache, wq, wo):
    B, Sq, D = x.shape
    Hq, Dh = 32, 128
    Hkv, Sk = k_cache.shape[1], k_cache.shape[2]
    W = min(4096, max(256, Sk // 4))
    rep = Hq // Hkv
    q = (lambda x, *d: x.permute(*d))((x @ wq).reshape(B, Sq, Hq, Dh), 0, 2, 1, 3)
    k = (lambda x, n, axis: torch.repeat_interleave(x, n, dim=axis))(k_cache[:, :, Sk - W:, :], rep, axis=1)
    v = (lambda x, n, axis: torch.repeat_interleave(x, n, dim=axis))(v_cache[:, :, Sk - W:, :], rep, axis=1)
    scores = torch.einsum("bhqd,bhkd->bhqk", q, k) * (Dh ** -0.5)
    p = _softmax(scores, axis=-1)
    o = torch.einsum("bhqk,bhkd->bhqd", p, v)
    return (lambda x, *d: x.permute(*d))(o, 0, 2, 1, 3).reshape(B, Sq, Hq * Dh) @ wo
```

```asm
; @launch grid=(256,1,1) block=(512,1,1) lds=152064
.amdgcn_target "amdgcn-amd-amdhsa--gfx950"
.text
.globl standalone__sliding_block_cached__sampling_kernel
.p2align 8
.type standalone__sliding_block_cached__sampling_kernel,@function
standalone__sliding_block_cached__sampling_kernel:
    s_cmp_ge_u32 s2, 256
    s_cbranch_scc1 L_end
    s_load_dwordx16 s[16:31], s[0:1], 0
    v_lshrrev_b32 v1, 6, v0
    v_and_b32 v2, 63, v0
    v_readfirstlane_b32 s3, v1
    s_and_b32 s4, s2, 7
    s_lshr_b32 s5, s2, 3
    s_lshr_b32 s6, s5, 3
    s_and_b32 s7, s5, 7
    s_xor_b32 s59, s7, 4
    s_bfe_u32 s8, s5, 0x20001
    s_and_b32 s9, s5, 1
    v_lshrrev_b32 v3, 4, v2
    v_and_b32 v4, 15, v2
    v_mov_b32 v5, 0
    v_mov_b32 v6, 1
    v_mov_b32 v1, 147456
    s_mov_b32 s11, 0x05040100
    s_mov_b32 s12, 0x07060302
    s_lshl_b32 s40, s4, 5
    s_add_u32 s41, s40, s5
    s_and_b32 s42, s41, 0xfffffff8
    s_cmp_ge_u32 s3, 4
    s_cbranch_scc1 L_B
    s_setprio 2
    s_cmp_lg_u32 s3, 0
    s_cbranch_scc1 L_P1
    v_lshl_add_u32 v7, v2, 2, v1
    ds_write_b32 v7, v5 offset:0
L_P1:
    v_lshlrev_b32 v8, 10, v4
    v_lshl_add_u32 v8, v3, 4, v8
    v_lshlrev_b32 v9, 16, v3
    v_lshl_add_u32 v9, v4, 3, v9
    s_lshl_b32 s14, s6, 14
    s_lshl_b32 s15, s3, 8
    s_add_u32 s45, s14, s15
    s_lshl_b32 s44, s3, 20
    s_lshl_b32 s14, s4, 10
    s_add_u32 s44, s44, s14
    s_xor_b32 s14, s7, 0
    s_lshl_b32 s14, s14, 7
    s_add_u32 s44, s44, s14
    s_lshl_b32 s47, s3, 15
    s_lshl_b32 s15, s6, 7
    s_waitcnt lgkmcnt(0)
    s_load_dword s10, s[30:31], s15
    s_mov_b32 s48, s22
    s_mov_b32 s49, s23
    s_mov_b32 s50, 4194304
    s_mov_b32 s51, 0x20000
    s_mov_b32 s52, s16
    s_mov_b32 s53, s17
    s_mov_b32 s54, 65536
    s_mov_b32 s55, 0x20000
    s_mov_b32 s32, s30
    s_mov_b32 s33, s31
    s_mov_b32 s34, 8388608
    s_mov_b32 s35, 0x20000
    s_cmp_eq_u32 s7, 3
    s_cbranch_scc1 L_A_q3
    buffer_load_dwordx2 v[32:33], v9, s[48:51], s44 offen
    s_add_u32 s44, s44, 8192
    buffer_load_dwordx2 v[34:35], v9, s[48:51], s44 offen
    s_add_u32 s44, s44, 8192
    buffer_load_dwordx2 v[36:37], v9, s[48:51], s44 offen
    s_add_u32 s44, s44, 8192
    buffer_load_dwordx2 v[38:39], v9, s[48:51], s44 offen
    s_add_u32 s44, s44, 8192
    buffer_load_dwordx2 v[40:41], v9, s[48:51], s44 offen
    s_add_u32 s44, s44, 8192
    buffer_load_dwordx2 v[42:43], v9, s[48:51], s44 offen
    s_add_u32 s44, s44, 8192
    buffer_load_dwordx2 v[44:45], v9, s[48:51], s44 offen
    s_add_u32 s44, s44, 8192
    buffer_load_dwordx2 v[46:47], v9, s[48:51], s44 offen
    s_add_u32 s44, s44, 8192
    s_add_u32 s44, s44, 196608
    buffer_load_dwordx4 v[16:19], v8, s[52:55], s45 offen offset:0
    buffer_load_dwordx4 v[20:23], v8, s[52:55], s45 offen offset:64
    buffer_load_dwordx4 v[24:27], v8, s[52:55], s45 offen offset:128
    buffer_load_dwordx4 v[28:31], v8, s[52:55], s45 offen offset:192
    s_barrier
    s_lshl_b32 s46, s42, 2
    s_add_u32 s46, s46, 32768
    v_lshlrev_b32 v145, 2, v2
    s_getreg_b32 s57, hwreg(HW_REG_XCC_ID, 0, 4)
    s_waitcnt lgkmcnt(0)
    s_add_u32 s10, s10, 0x9e3779b9
    s_and_b32 s14, s10, 0xfffffff0
    s_or_b32 s14, s14, s57
    v_mov_b32 v144, s14
    s_lshl_b32 s14, s41, 2
    s_add_u32 s14, s14, 32768
    s_mov_b64 exec, 1
    buffer_store_dword v144, v5, s[32:35], s14 offen
    s_mov_b64 exec, -1
    v_mov_b32 v8, s10
    s_waitcnt vmcnt(1)
    s_mov_b64 exec, 0xff
    buffer_load_dword v146, v145, s[32:35], s46 offen sc1
    s_mov_b64 exec, -1
    buffer_load_dwordx2 v[48:49], v9, s[48:51], s44 offen
    s_add_u32 s44, s44, 8192
    buffer_load_dwordx2 v[50:51], v9, s[48:51], s44 offen
    s_add_u32 s44, s44, 8192
    buffer_load_dwordx2 v[52:53], v9, s[48:51], s44 offen
    s_add_u32 s44, s44, 8192
    buffer_load_dwordx2 v[54:55], v9, s[48:51], s44 offen
    s_add_u32 s44, s44, 8192
    buffer_load_dwordx2 v[56:57], v9, s[48:51], s44 offen
    s_add_u32 s44, s44, 8192
    buffer_load_dwordx2 v[58:59], v9, s[48:51], s44 offen
    s_add_u32 s44, s44, 8192
    buffer_load_dwordx2 v[60:61], v9, s[48:51], s44 offen
    s_add_u32 s44, s44, 8192
    buffer_load_dwordx2 v[62:63], v9, s[48:51], s44 offen
    s_add_u32 s44, s44, 8192
    s_add_u32 s44, s44, 196608
    v_perm_b32 v96, v34, v32, s11
    v_perm_b32 v97, v38, v36, s11
    v_perm_b32 v98, v42, v40, s11
    v_perm_b32 v99, v46, v44, s11
    v_perm_b32 v100, v34, v32, s12
    v_perm_b32 v101, v38, v36, s12
    v_perm_b32 v102, v42, v40, s12
    v_perm_b32 v103, v46, v44, s12
    v_perm_b32 v104, v35, v33, s11
    v_perm_b32 v105, v39, v37, s11
    v_perm_b32 v106, v43, v41, s11
    v_perm_b32 v107, v47, v45, s11
    v_perm_b32 v108, v35, v33, s12
    v_perm_b32 v109, v39, v37, s12
    v_perm_b32 v110, v43, v41, s12
    v_perm_b32 v111, v47, v45, s12
    v_mfma_f32_16x16x32_bf16 v[128:131], v[16:19], v[96:99], 0
    v_mfma_f32_16x16x32_bf16 v[132:135], v[16:19], v[100:103], 0
    v_mfma_f32_16x16x32_bf16 v[136:139], v[16:19], v[104:107], 0
    v_mfma_f32_16x16x32_bf16 v[140:143], v[16:19], v[108:111], 0
    s_waitcnt vmcnt(0)
    buffer_load_dwordx2 v[64:65], v9, s[48:51], s44 offen
    s_add_u32 s44, s44, 8192
    buffer_load_dwordx2 v[66:67], v9, s[48:51], s44 offen
    s_add_u32 s44, s44, 8192
    buffer_load_dwordx2 v[68:69], v9, s[48:51], s44 offen
    s_add_u32 s44, s44, 8192
    buffer_load_dwordx2 v[70:71], v9, s[48:51], s44 offen
    s_add_u32 s44, s44, 8192
    buffer_load_dwordx2 v[72:73], v9, s[48:51], s44 offen
    s_add_u32 s44, s44, 8192
    buffer_load_dwordx2 v[74:75], v9, s[48:51], s44 offen
    s_add_u32 s44, s44, 8192
    buffer_load_dwordx2 v[76:77], v9, s[48:51], s44 offen
    s_add_u32 s44, s44, 8192
    buffer_load_dwordx2 v[78:79], v9, s[48:51], s44 offen
    s_add_u32 s44, s44, 8192
    s_add_u32 s44, s44, 196608
    v_perm_b32 v112, v50, v48, s11
    v_perm_b32 v113, v54, v52, s11
    v_perm_b32 v114, v58, v56, s11
    v_perm_b32 v115, v62, v60, s11
    v_perm_b32 v116, v50, v48, s12
    v_perm_b32 v117, v54, v52, s12
    v_perm_b32 v118, v58, v56, s12
    v_perm_b32 v119, v62, v60, s12
    v_perm_b32 v120, v51, v49, s11
    v_perm_b32 v121, v55, v53, s11
    v_perm_b32 v122, v59, v57, s11
    v_perm_b32 v123, v63, v61, s11
    v_perm_b32 v124, v51, v49, s12
    v_perm_b32 v125, v55, v53, s12
    v_perm_b32 v126, v59, v57, s12
    v_perm_b32 v127, v63, v61, s12
    v_mfma_f32_16x16x32_bf16 v[128:131], v[20:23], v[112:115], v[128:131]
    v_mfma_f32_16x16x32_bf16 v[132:135], v[20:23], v[116:119], v[132:135]
    v_mfma_f32_16x16x32_bf16 v[136:139], v[20:23], v[120:123], v[136:139]
    v_mfma_f32_16x16x32_bf16 v[140:143], v[20:23], v[124:127], v[140:143]
    s_waitcnt vmcnt(0)
    buffer_load_dwordx2 v[80:81], v9, s[48:51], s44 offen
    s_add_u32 s44, s44, 8192
    buffer_load_dwordx2 v[82:83], v9, s[48:51], s44 offen
    s_add_u32 s44, s44, 8192
    buffer_load_dwordx2 v[84:85], v9, s[48:51], s44 offen
    s_add_u32 s44, s44, 8192
    buffer_load_dwordx2 v[86:87], v9, s[48:51], s44 offen
    s_add_u32 s44, s44, 8192
    buffer_load_dwordx2 v[88:89], v9, s[48:51], s44 offen
    s_add_u32 s44, s44, 8192
    buffer_load_dwordx2 v[90:91], v9, s[48:51], s44 offen
    s_add_u32 s44, s44, 8192
    buffer_load_dwordx2 v[92:93], v9, s[48:51], s44 offen
    s_add_u32 s44, s44, 8192
    buffer_load_dwordx2 v[94:95], v9, s[48:51], s44 offen
    s_add_u32 s44, s44, 8192
    s_mov_b32 s45, 0
    s_mov_b32 s58, 0
    s_branch L_A_xchka
L_A_xretrya:
    s_mov_b64 exec, 0xff
    buffer_load_dword v146, v145, s[32:35], s46 offen sc1
    s_mov_b64 exec, -1
    s_waitcnt vmcnt(0)
L_A_xchka:
    s_mov_b64 exec, 0xff
    v_xor_b32 v147, v146, v8
    v_and_b32 v147, 0xfffffff0, v147
    v_cmp_ne_u32 vcc, 0, v147
    s_mov_b64 exec, -1
    s_cbranch_vccz L_A_xoka
    s_add_u32 s45, s45, 1
    s_cmp_lt_u32 s45, 4
    s_cbranch_scc1 L_A_xretrya
    s_branch L_A_xdonea
L_A_xoka:
    s_mov_b64 exec, 0xff
    v_and_b32 v147, 15, v146
    v_cmp_ne_u32 vcc, s57, v147
    s_mov_b64 exec, -1
    s_cmp_eq_u64 vcc, 0
    s_cselect_b32 s58, 1, 0
L_A_xdonea:
    v_mov_b32 v148, -1
    v_mov_b32 v149, -1
    v_mov_b32 v150, -1
    v_mov_b32 v151, -1
    v_lshlrev_b32 v7, 4, v2
    s_lshl_b32 s43, s41, 12
    s_lshl_b32 s14, s3, 10
    s_add_u32 s43, s43, s14
    s_add_u32 s46, s43, 3145728
    s_cmp_eq_u32 s58, 1
    s_cbranch_scc1 Ls1_f
    buffer_store_dwordx4 v[148:151], v7, s[32:35], s46 offen sc1
    s_branch Ls1_d
Ls1_f:
    buffer_store_dwordx4 v[148:151], v7, s[32:35], s46 offen
Ls1_d:
    v_perm_b32 v96, v66, v64, s11
    v_perm_b32 v97, v70, v68, s11
    v_perm_b32 v98, v74, v72, s11
    v_perm_b32 v99, v78, v76, s11
    v_perm_b32 v100, v66, v64, s12
    v_perm_b32 v101, v70, v68, s12
    v_perm_b32 v102, v74, v72, s12
    v_perm_b32 v103, v78, v76, s12
    v_perm_b32 v104, v67, v65, s11
    v_perm_b32 v105, v71, v69, s11
    v_perm_b32 v106, v75, v73, s11
    v_perm_b32 v107, v79, v77, s11
    v_perm_b32 v108, v67, v65, s12
    v_perm_b32 v109, v71, v69, s12
    v_perm_b32 v110, v75, v73, s12
    v_perm_b32 v111, v79, v77, s12
    v_mfma_f32_16x16x32_bf16 v[128:131], v[24:27], v[96:99], v[128:131]
    v_mfma_f32_16x16x32_bf16 v[132:135], v[24:27], v[100:103], v[132:135]
    v_mfma_f32_16x16x32_bf16 v[136:139], v[24:27], v[104:107], v[136:139]
    v_mfma_f32_16x16x32_bf16 v[140:143], v[24:27], v[108:111], v[140:143]
    s_waitcnt vmcnt(1)
    v_perm_b32 v112, v82, v80, s11
    v_perm_b32 v113, v86, v84, s11
    v_perm_b32 v114, v90, v88, s11
    v_perm_b32 v115, v94, v92, s11
    v_perm_b32 v116, v82, v80, s12
    v_perm_b32 v117, v86, v84, s12
    v_perm_b32 v118, v90, v88, s12
    v_perm_b32 v119, v94, v92, s12
    v_perm_b32 v120, v83, v81, s11
    v_perm_b32 v121, v87, v85, s11
    v_perm_b32 v122, v91, v89, s11
    v_perm_b32 v123, v95, v93, s11
    v_perm_b32 v124, v83, v81, s12
    v_perm_b32 v125, v87, v85, s12
    v_perm_b32 v126, v91, v89, s12
    v_perm_b32 v127, v95, v93, s12
    v_mfma_f32_16x16x32_bf16 v[128:131], v[28:31], v[112:115], v[128:131]
    v_mfma_f32_16x16x32_bf16 v[132:135], v[28:31], v[116:119], v[132:135]
    v_mfma_f32_16x16x32_bf16 v[136:139], v[28:31], v[120:123], v[136:139]
    v_mfma_f32_16x16x32_bf16 v[140:143], v[28:31], v[124:127], v[140:143]
    s_branch L_A_qdone
L_A_q3:
    buffer_load_dwordx2 v[32:33], v9, s[48:51], s44 offen
    s_add_u32 s44, s44, 8192
    buffer_load_dwordx2 v[34:35], v9, s[48:51], s44 offen
    s_add_u32 s44, s44, 8192
    buffer_load_dwordx2 v[36:37], v9, s[48:51], s44 offen
    s_add_u32 s44, s44, 8192
    buffer_load_dwordx2 v[38:39], v9, s[48:51], s44 offen
    s_add_u32 s44, s44, 8192
    buffer_load_dwordx2 v[40:41], v9, s[48:51], s44 offen
    s_add_u32 s44, s44, 8192
    buffer_load_dwordx2 v[42:43], v9, s[48:51], s44 offen
    s_add_u32 s44, s44, 8192
    buffer_load_dwordx2 v[44:45], v9, s[48:51], s44 offen
    s_add_u32 s44, s44, 8192
    buffer_load_dwordx2 v[46:47], v9, s[48:51], s44 offen
    s_add_u32 s44, s44, 8192
    s_add_u32 s44, s44, 196608
    buffer_load_dwordx4 v[16:19], v8, s[52:55], s45 offen offset:0
    buffer_load_dwordx4 v[20:23], v8, s[52:55], s45 offen offset:64
    buffer_load_dwordx4 v[24:27], v8, s[52:55], s45 offen offset:128
    buffer_load_dwordx4 v[28:31], v8, s[52:55], s45 offen offset:192
    s_barrier
    s_lshl_b32 s46, s42, 2
    s_add_u32 s46, s46, 32768
    v_lshlrev_b32 v145, 2, v2
    buffer_load_dwordx2 v[48:49], v9, s[48:51], s44 offen
    s_add_u32 s44, s44, 8192
    buffer_load_dwordx2 v[50:51], v9, s[48:51], s44 offen
    s_add_u32 s44, s44, 8192
    buffer_load_dwordx2 v[52:53], v9, s[48:51], s44 offen
    s_add_u32 s44, s44, 8192
    buffer_load_dwordx2 v[54:55], v9, s[48:51], s44 offen
    s_add_u32 s44, s44, 8192
    buffer_load_dwordx2 v[56:57], v9, s[48:51], s44 offen
    s_add_u32 s44, s44, 8192
    buffer_load_dwordx2 v[58:59], v9, s[48:51], s44 offen
    s_add_u32 s44, s44, 8192
    buffer_load_dwordx2 v[60:61], v9, s[48:51], s44 offen
    s_add_u32 s44, s44, 8192
    buffer_load_dwordx2 v[62:63], v9, s[48:51], s44 offen
    s_add_u32 s44, s44, 8192
    s_add_u32 s44, s44, 196608
    s_getreg_b32 s57, hwreg(HW_REG_XCC_ID, 0, 4)
    s_waitcnt lgkmcnt(0)
    s_add_u32 s10, s10, 0x9e3779b9
    s_and_b32 s14, s10, 0xfffffff0
    s_or_b32 s14, s14, s57
    v_mov_b32 v144, s14
    s_lshl_b32 s14, s41, 2
    s_add_u32 s14, s14, 32768
    s_mov_b64 exec, 1
    buffer_store_dword v144, v5, s[32:35], s14 offen
    s_mov_b64 exec, -1
    v_mov_b32 v8, s10
    s_waitcnt vmcnt(9)
    s_mov_b64 exec, 0xff
    buffer_load_dword v146, v145, s[32:35], s46 offen sc1
    s_mov_b64 exec, -1
    buffer_load_dwordx2 v[64:65], v9, s[48:51], s44 offen
    s_add_u32 s44, s44, 8192
    buffer_load_dwordx2 v[66:67], v9, s[48:51], s44 offen
    s_add_u32 s44, s44, 8192
    buffer_load_dwordx2 v[68:69], v9, s[48:51], s44 offen
    s_add_u32 s44, s44, 8192
    buffer_load_dwordx2 v[70:71], v9, s[48:51], s44 offen
    s_add_u32 s44, s44, 8192
    buffer_load_dwordx2 v[72:73], v9, s[48:51], s44 offen
    s_add_u32 s44, s44, 8192
    buffer_load_dwordx2 v[74:75], v9, s[48:51], s44 offen
    s_add_u32 s44, s44, 8192
    buffer_load_dwordx2 v[76:77], v9, s[48:51], s44 offen
    s_add_u32 s44, s44, 8192
    buffer_load_dwordx2 v[78:79], v9, s[48:51], s44 offen
    s_add_u32 s44, s44, 8192
    s_add_u32 s44, s44, 196608
    v_perm_b32 v96, v34, v32, s11
    v_perm_b32 v97, v38, v36, s11
    v_perm_b32 v98, v42, v40, s11
    v_perm_b32 v99, v46, v44, s11
    v_perm_b32 v100, v34, v32, s12
    v_perm_b32 v101, v38, v36, s12
    v_perm_b32 v102, v42, v40, s12
    v_perm_b32 v103, v46, v44, s12
    v_perm_b32 v104, v35, v33, s11
    v_perm_b32 v105, v39, v37, s11
    v_perm_b32 v106, v43, v41, s11
    v_perm_b32 v107, v47, v45, s11
    v_perm_b32 v108, v35, v33, s12
    v_perm_b32 v109, v39, v37, s12
    v_perm_b32 v110, v43, v41, s12
    v_perm_b32 v111, v47, v45, s12
    v_mfma_f32_16x16x32_bf16 v[128:131], v[16:19], v[96:99], 0
    v_mfma_f32_16x16x32_bf16 v[132:135], v[16:19], v[100:103], 0
    v_mfma_f32_16x16x32_bf16 v[136:139], v[16:19], v[104:107], 0
    v_mfma_f32_16x16x32_bf16 v[140:143], v[16:19], v[108:111], 0
    s_waitcnt vmcnt(10)
    buffer_load_dwordx2 v[80:81], v9, s[48:51], s44 offen
    s_add_u32 s44, s44, 8192
    buffer_load_dwordx2 v[82:83], v9, s[48:51], s44 offen
    s_add_u32 s44, s44, 8192
    buffer_load_dwordx2 v[84:85], v9, s[48:51], s44 offen
    s_add_u32 s44, s44, 8192
    buffer_load_dwordx2 v[86:87], v9, s[48:51], s44 offen
    s_add_u32 s44, s44, 8192
    buffer_load_dwordx2 v[88:89], v9, s[48:51], s44 offen
    s_add_u32 s44, s44, 8192
    buffer_load_dwordx2 v[90:91], v9, s[48:51], s44 offen
    s_add_u32 s44, s44, 8192
    buffer_load_dwordx2 v[92:93], v9, s[48:51], s44 offen
    s_add_u32 s44, s44, 8192
    buffer_load_dwordx2 v[94:95], v9, s[48:51], s44 offen
    s_add_u32 s44, s44, 8192
    v_perm_b32 v112, v50, v48, s11
    v_perm_b32 v113, v54, v52, s11
    v_perm_b32 v114, v58, v56, s11
    v_perm_b32 v115, v62, v60, s11
    v_perm_b32 v116, v50, v48, s12
    v_perm_b32 v117, v54, v52, s12
    v_perm_b32 v118, v58, v56, s12
    v_perm_b32 v119, v62, v60, s12
    v_perm_b32 v120, v51, v49, s11
    v_perm_b32 v121, v55, v53, s11
    v_perm_b32 v122, v59, v57, s11
    v_perm_b32 v123, v63, v61, s11
    v_perm_b32 v124, v51, v49, s12
    v_perm_b32 v125, v55, v53, s12
    v_perm_b32 v126, v59, v57, s12
    v_perm_b32 v127, v63, v61, s12
    v_mfma_f32_16x16x32_bf16 v[128:131], v[20:23], v[112:115], v[128:131]
    v_mfma_f32_16x16x32_bf16 v[132:135], v[20:23], v[116:119], v[132:135]
    v_mfma_f32_16x16x32_bf16 v[136:139], v[20:23], v[120:123], v[136:139]
    v_mfma_f32_16x16x32_bf16 v[140:143], v[20:23], v[124:127], v[140:143]
    s_waitcnt vmcnt(8)
    s_mov_b32 s45, 0
    s_mov_b32 s58, 0
    s_branch L_A_xchkb
L_A_xretryb:
    s_mov_b64 exec, 0xff
    buffer_load_dword v146, v145, s[32:35], s46 offen sc1
    s_mov_b64 exec, -1
    s_waitcnt vmcnt(0)
L_A_xchkb:
    s_mov_b64 exec, 0xff
    v_xor_b32 v147, v146, v8
    v_and_b32 v147, 0xfffffff0, v147
    v_cmp_ne_u32 vcc, 0, v147
    s_mov_b64 exec, -1
    s_cbranch_vccz L_A_xokb
    s_add_u32 s45, s45, 1
    s_cmp_lt_u32 s45, 4
    s_cbranch_scc1 L_A_xretryb
    s_branch L_A_xdoneb
L_A_xokb:
    s_mov_b64 exec, 0xff
    v_and_b32 v147, 15, v146
    v_cmp_ne_u32 vcc, s57, v147
    s_mov_b64 exec, -1
    s_cmp_eq_u64 vcc, 0
    s_cselect_b32 s58, 1, 0
L_A_xdoneb:
    v_mov_b32 v148, -1
    v_mov_b32 v149, -1
    v_mov_b32 v150, -1
    v_mov_b32 v151, -1
    v_lshlrev_b32 v7, 4, v2
    s_lshl_b32 s43, s41, 12
    s_lshl_b32 s14, s3, 10
    s_add_u32 s43, s43, s14
    s_add_u32 s46, s43, 3145728
    s_cmp_eq_u32 s58, 1
    s_cbranch_scc1 Ls2_f
    buffer_store_dwordx4 v[148:151], v7, s[32:35], s46 offen sc1
    s_branch Ls2_d
Ls2_f:
    buffer_store_dwordx4 v[148:151], v7, s[32:35], s46 offen
Ls2_d:
    v_perm_b32 v96, v66, v64, s11
    v_perm_b32 v97, v70, v68, s11
    v_perm_b32 v98, v74, v72, s11
    v_perm_b32 v99, v78, v76, s11
    v_perm_b32 v100, v66, v64, s12
    v_perm_b32 v101, v70, v68, s12
    v_perm_b32 v102, v74, v72, s12
    v_perm_b32 v103, v78, v76, s12
    v_perm_b32 v104, v67, v65, s11
    v_perm_b32 v105, v71, v69, s11
    v_perm_b32 v106, v75, v73, s11
    v_perm_b32 v107, v79, v77, s11
    v_perm_b32 v108, v67, v65, s12
    v_perm_b32 v109, v71, v69, s12
    v_perm_b32 v110, v75, v73, s12
    v_perm_b32 v111, v79, v77, s12
    v_mfma_f32_16x16x32_bf16 v[128:131], v[24:27], v[96:99], v[128:131]
    v_mfma_f32_16x16x32_bf16 v[132:135], v[24:27], v[100:103], v[132:135]
    v_mfma_f32_16x16x32_bf16 v[136:139], v[24:27], v[104:107], v[136:139]
    v_mfma_f32_16x16x32_bf16 v[140:143], v[24:27], v[108:111], v[140:143]
    s_waitcnt vmcnt(1)
    v_perm_b32 v112, v82, v80, s11
    v_perm_b32 v113, v86, v84, s11
    v_perm_b32 v114, v90, v88, s11
    v_perm_b32 v115, v94, v92, s11
    v_perm_b32 v116, v82, v80, s12
    v_perm_b32 v117, v86, v84, s12
    v_perm_b32 v118, v90, v88, s12
    v_perm_b32 v119, v94, v92, s12
    v_perm_b32 v120, v83, v81, s11
    v_perm_b32 v121, v87, v85, s11
    v_perm_b32 v122, v91, v89, s11
    v_perm_b32 v123, v95, v93, s11
    v_perm_b32 v124, v83, v81, s12
    v_perm_b32 v125, v87, v85, s12
    v_perm_b32 v126, v91, v89, s12
    v_perm_b32 v127, v95, v93, s12
    v_mfma_f32_16x16x32_bf16 v[128:131], v[28:31], v[112:115], v[128:131]
    v_mfma_f32_16x16x32_bf16 v[132:135], v[28:31], v[116:119], v[132:135]
    v_mfma_f32_16x16x32_bf16 v[136:139], v[28:31], v[120:123], v[136:139]
    v_mfma_f32_16x16x32_bf16 v[140:143], v[28:31], v[124:127], v[140:143]
L_A_qdone:
    v_lshlrev_b32 v9, 2, v2
    s_lshl_b32 s14, s3, 10
    s_add_u32 s14, s14, 131072
    v_add_u32 v7, s14, v9
    s_nop 1
    ds_write2st64_b32 v7, v128, v132 offset0:0 offset1:1
    s_nop 0
    ds_write2st64_b32 v7, v136, v140 offset0:2 offset1:3
    ds_write2st64_b32 v7, v129, v133 offset0:16 offset1:17
    ds_write2st64_b32 v7, v137, v141 offset0:18 offset1:19
    ds_write2st64_b32 v7, v130, v134 offset0:32 offset1:33
    ds_write2st64_b32 v7, v138, v142 offset0:34 offset1:35
    ds_write2st64_b32 v7, v131, v135 offset0:48 offset1:49
    ds_write2st64_b32 v7, v139, v143 offset0:50 offset1:51
    v_mov_b32 v10, s58
    ds_write_b32 v1, v10 offset:60
    s_waitcnt lgkmcnt(0)
    s_mov_b64 exec, 1
    ds_add_u32 v1, v6 offset:0
    s_mov_b64 exec, -1
    s_mov_b32 s15, 0
Lw3:
    ds_read_b32 v10, v1 offset:0
    s_add_u32 s15, s15, 1
    s_waitcnt lgkmcnt(0)
    v_readfirstlane_b32 s14, v10
    s_cmp_gt_u32 s15, 480000
    s_cbranch_scc1 Lw3_o
    s_cmp_ge_u32 s14, 4
    s_cbranch_scc0 Lw3
Lw3_o:
    s_lshl_b32 s14, s3, 12
    s_add_u32 s14, s14, 131072
    v_add_u32 v7, s14, v9
    ds_read2st64_b32 v[152:153], v7 offset0:0 offset1:1
    ds_read2st64_b32 v[154:155], v7 offset0:2 offset1:3
    ds_read2st64_b32 v[156:157], v7 offset0:4 offset1:5
    ds_read2st64_b32 v[158:159], v7 offset0:6 offset1:7
    ds_read2st64_b32 v[160:161], v7 offset0:8 offset1:9
    ds_read2st64_b32 v[162:163], v7 offset0:10 offset1:11
    ds_read2st64_b32 v[164:165], v7 offset0:12 offset1:13
    ds_read2st64_b32 v[166:167], v7 offset0:14 offset1:15
    v_lshlrev_b32 v9, 10, v3
    v_and_b32 v10, 1, v4
    v_lshl_add_u32 v9, v10, 9, v9
    v_lshrrev_b32 v10, 3, v4
    v_lshl_add_u32 v9, v10, 8, v9
    v_bfe_u32 v10, v4, 1, 2
    v_lshl_add_u32 v9, v10, 4, v9
    s_lshl_b32 s43, s41, 12
    s_lshl_b32 s14, s3, 6
    s_add_u32 s43, s43, s14
    s_add_u32 s43, s43, 65536
    s_waitcnt lgkmcnt(0)
    v_add_f32 v152, v152, v156
    v_add_f32 v160, v160, v164
    v_add_f32 v153, v153, v157
    v_add_f32 v161, v161, v165
    v_add_f32 v154, v154, v158
    v_add_f32 v162, v162, v166
    v_add_f32 v155, v155, v159
    v_add_f32 v163, v163, v167
    v_add_f32 v152, v152, v160
    v_add_f32 v153, v153, v161
    v_add_f32 v154, v154, v162
    v_add_f32 v155, v155, v163
    v_cvt_pk_bf16_f32 v156, v152, v153
    v_cvt_pk_bf16_f32 v157, v154, v155
    v_perm_b32 v160, v156, v8, s11
    v_perm_b32 v161, v156, v8, s12
    v_perm_b32 v162, v157, v8, s11
    v_perm_b32 v163, v157, v8, s12
    s_waitcnt vmcnt(0)
    v_lshlrev_b32 v7, 4, v2
    buffer_load_dwordx4 v[248:251], v7, s[32:35], s46 offen sc1
    s_cmp_eq_u32 s58, 1
    s_cbranch_scc1 Ls4_f
    buffer_store_dwordx4 v[160:163], v9, s[32:35], s43 offen sc1
    s_branch Ls4_d
Ls4_f:
    buffer_store_dwordx4 v[160:163], v9, s[32:35], s43 offen
Ls4_d:
    v_lshrrev_b32 v9, 2, v4
    v_lshlrev_b32 v9, 13, v9
    v_and_b32 v10, 3, v4
    v_lshl_add_u32 v9, v10, 6, v9
    v_lshl_add_u32 v9, v3, 4, v9
    s_lshl_b32 s43, s42, 12
    s_lshl_b32 s14, s8, 10
    s_add_u32 s43, s43, s14
    s_add_u32 s43, s43, 65536
    s_lshr_b32 s14, s3, 1
    s_lshl_b32 s14, s14, 12
    s_add_u32 s43, s43, s14
    s_and_b32 s14, s3, 1
    s_lshl_b32 s14, s14, 8
    s_add_u32 s43, s43, s14
    s_mov_b32 s45, 0
L_A_qretry:
    buffer_load_dwordx4 v[176:179], v9, s[32:35], s43 offen offset:0 sc1
    buffer_load_dwordx4 v[180:183], v9, s[32:35], s43 offen offset:512 sc1
    v_mov_b32 v10, 0
    s_waitcnt vmcnt(0)
    v_perm_b32 v11, v177, v176, s11
    v_xor_b32 v11, v11, v8
    v_or_b32 v10, v10, v11
    v_perm_b32 v11, v179, v178, s11
    v_xor_b32 v11, v11, v8
    v_or_b32 v10, v10, v11
    v_perm_b32 v11, v181, v180, s11
    v_xor_b32 v11, v11, v8
    v_or_b32 v10, v10, v11
    v_perm_b32 v11, v183, v182, s11
    v_xor_b32 v11, v11, v8
    v_or_b32 v10, v10, v11
    v_cmp_ne_u32 vcc, 0, v10
    s_add_u32 s45, s45, 1
    s_cmp_gt_u32 s45, 30000
    s_cbranch_scc1 L_A_qok
    s_cbranch_vccnz L_A_qretry
L_A_qok:
    v_perm_b32 v184, v177, v176, s12
    v_perm_b32 v185, v179, v178, s12
    v_perm_b32 v186, v181, v180, s12
    v_perm_b32 v187, v183, v182, s12
    v_lshlrev_b32 v9, 4, v2
    s_lshl_b32 s14, s3, 10
    s_add_u32 s14, s14, 147968
    v_add_u32 v10, s14, v9
    ds_write_b128 v10, v[184:187]
    v_add_u32 v10, 0, v3
    v_xor_b32 v10, v10, v4
    v_lshlrev_b32 v10, 4, v10
    v_lshl_add_u32 v10, v4, 8, v10
    v_add_u32 v12, s47, v10
    v_add_u32 v10, 4, v3
    v_xor_b32 v10, v10, v4
    v_lshlrev_b32 v10, 4, v10
    v_lshl_add_u32 v10, v4, 8, v10
    v_add_u32 v13, s47, v10
    v_add_u32 v10, 8, v3
    v_xor_b32 v10, v10, v4
    v_lshlrev_b32 v10, 4, v10
    v_lshl_add_u32 v10, v4, 8, v10
    v_add_u32 v14, s47, v10
    v_add_u32 v10, 12, v3
    v_xor_b32 v10, v10, v4
    v_lshlrev_b32 v10, 4, v10
    v_lshl_add_u32 v10, v4, 8, v10
    v_add_u32 v15, s47, v10
    s_waitcnt lgkmcnt(0)
    s_mov_b64 exec, 1
    ds_add_u32 v1, v6 offset:40
    s_mov_b64 exec, -1
    s_mov_b32 s48, s24
    s_mov_b32 s49, s25
    s_mov_b32 s50, 4194304
    s_mov_b32 s51, 0x20000
    v_lshlrev_b32 v16, 15, v3
    v_lshl_add_u32 v16, v4, 3, v16
    s_lshl_b32 s46, s4, 2
    s_add_u32 s46, s46, s3
    s_lshl_b32 s46, s46, 17
    s_lshl_b32 s15, s59, 7
    s_add_u32 s46, s46, s15
    s_mov_b32 s15, 0
Lw5:
    ds_read_b32 v10, v1 offset:40
    s_add_u32 s15, s15, 1
    s_waitcnt lgkmcnt(0)
    v_readfirstlane_b32 s14, v10
    s_cmp_gt_u32 s15, 480000
    s_cbranch_scc1 Lw5_o
    s_cmp_ge_u32 s14, 4
    s_cbranch_scc0 Lw5
Lw5_o:
    v_add_u32 v10, 147968, v9
    ds_read_b128 v[160:163], v10 offset:0
    ds_read_b128 v[164:167], v10 offset:1024
    ds_read_b128 v[168:171], v10 offset:2048
    ds_read_b128 v[172:175], v10 offset:3072
    s_lshl_b32 s14, s3, 2
    v_add_u32 v7, s14, v1
    s_mov_b32 s15, 0
Lw6:
    ds_read_b32 v10, v7 offset:44
    s_add_u32 s15, s15, 1
    s_waitcnt lgkmcnt(0)
    v_readfirstlane_b32 s14, v10
    s_cmp_gt_u32 s15, 480000
    s_cbranch_scc1 Lw6_o
    s_cmp_ge_u32 s14, 1
    s_cbranch_scc0 Lw6
Lw6_o:
    ds_read_b128 v[96:99], v12 offset:0
    ds_read_b128 v[100:103], v13 offset:0
    ds_read_b128 v[104:107], v14 offset:0
    ds_read_b128 v[108:111], v15 offset:0
    ds_read_b128 v[112:115], v12 offset:4096
    ds_read_b128 v[116:119], v13 offset:4096
    ds_read_b128 v[120:123], v14 offset:4096
    ds_read_b128 v[124:127], v15 offset:4096
    ds_read_b128 v[128:131], v12 offset:8192
    ds_read_b128 v[132:135], v13 offset:8192
    ds_read_b128 v[136:139], v14 offset:8192
    ds_read_b128 v[140:143], v15 offset:8192
    ds_read_b128 v[144:147], v12 offset:12288
    ds_read_b128 v[148:151], v13 offset:12288
    ds_read_b128 v[152:155], v14 offset:12288
    ds_read_b128 v[156:159], v15 offset:12288
    s_waitcnt lgkmcnt(8)
    v_mfma_f32_16x16x32_bf16 v[192:195], v[96:99], v[160:163], 0
    v_mfma_f32_16x16x32_bf16 v[192:195], v[100:103], v[164:167], v[192:195]
    v_mfma_f32_16x16x32_bf16 v[192:195], v[104:107], v[168:171], v[192:195]
    v_mfma_f32_16x16x32_bf16 v[192:195], v[108:111], v[172:175], v[192:195]
    v_mfma_f32_16x16x32_bf16 v[196:199], v[112:115], v[160:163], 0
    v_mfma_f32_16x16x32_bf16 v[196:199], v[116:119], v[164:167], v[196:199]
    v_mfma_f32_16x16x32_bf16 v[196:199], v[120:123], v[168:171], v[196:199]
    v_mfma_f32_16x16x32_bf16 v[196:199], v[124:127], v[172:175], v[196:199]
    ds_read_b128 v[96:99], v12 offset:16384
    ds_read_b128 v[100:103], v13 offset:16384
    ds_read_b128 v[104:107], v14 offset:16384
    ds_read_b128 v[108:111], v15 offset:16384
    ds_read_b128 v[112:115], v12 offset:20480
    ds_read_b128 v[116:119], v13 offset:20480
    ds_read_b128 v[120:123], v14 offset:20480
    ds_read_b128 v[124:127], v15 offset:20480
    s_waitcnt lgkmcnt(8)
    v_mfma_f32_16x16x32_bf16 v[200:203], v[128:131], v[160:163], 0
    v_mfma_f32_16x16x32_bf16 v[200:203], v[132:135], v[164:167], v[200:203]
    v_mfma_f32_16x16x32_bf16 v[200:203], v[136:139], v[168:171], v[200:203]
    v_mfma_f32_16x16x32_bf16 v[200:203], v[140:143], v[172:175], v[200:203]
    v_mfma_f32_16x16x32_bf16 v[204:207], v[144:147], v[160:163], 0
    v_mfma_f32_16x16x32_bf16 v[204:207], v[148:151], v[164:167], v[204:207]
    v_mfma_f32_16x16x32_bf16 v[204:207], v[152:155], v[168:171], v[204:207]
    v_mfma_f32_16x16x32_bf16 v[204:207], v[156:159], v[172:175], v[204:207]
    ds_read_b128 v[128:131], v12 offset:24576
    ds_read_b128 v[132:135], v13 offset:24576
    ds_read_b128 v[136:139], v14 offset:24576
    ds_read_b128 v[140:143], v15 offset:24576
    ds_read_b128 v[144:147], v12 offset:28672
    ds_read_b128 v[148:151], v13 offset:28672
    ds_read_b128 v[152:155], v14 offset:28672
    ds_read_b128 v[156:159], v15 offset:28672
    s_waitcnt lgkmcnt(8)
    v_mfma_f32_16x16x32_bf16 v[208:211], v[96:99], v[160:163], 0
    v_mfma_f32_16x16x32_bf16 v[208:211], v[100:103], v[164:167], v[208:211]
    v_mfma_f32_16x16x32_bf16 v[208:211], v[104:107], v[168:171], v[208:211]
    v_mfma_f32_16x16x32_bf16 v[208:211], v[108:111], v[172:175], v[208:211]
    v_mfma_f32_16x16x32_bf16 v[212:215], v[112:115], v[160:163], 0
    v_mfma_f32_16x16x32_bf16 v[212:215], v[116:119], v[164:167], v[212:215]
    v_mfma_f32_16x16x32_bf16 v[212:215], v[120:123], v[168:171], v[212:215]
    v_mfma_f32_16x16x32_bf16 v[212:215], v[124:127], v[172:175], v[212:215]
    s_waitcnt lgkmcnt(0)
    v_mfma_f32_16x16x32_bf16 v[216:219], v[128:131], v[160:163], 0
    v_mfma_f32_16x16x32_bf16 v[216:219], v[132:135], v[164:167], v[216:219]
    v_mfma_f32_16x16x32_bf16 v[216:219], v[136:139], v[168:171], v[216:219]
    v_mfma_f32_16x16x32_bf16 v[216:219], v[140:143], v[172:175], v[216:219]
    v_mfma_f32_16x16x32_bf16 v[220:223], v[144:147], v[160:163], 0
    v_mfma_f32_16x16x32_bf16 v[220:223], v[148:151], v[164:167], v[220:223]
    v_mfma_f32_16x16x32_bf16 v[220:223], v[152:155], v[168:171], v[220:223]
    v_mfma_f32_16x16x32_bf16 v[220:223], v[156:159], v[172:175], v[220:223]
    s_mov_b32 s13, 0x3e0293ee
    v_max3_f32 v10, v192, v193, v194
    v_max3_f32 v10, v10, v195, v196
    v_max3_f32 v10, v10, v197, v198
    v_max3_f32 v10, v10, v199, v200
    v_max3_f32 v10, v10, v201, v202
    v_max3_f32 v10, v10, v203, v204
    v_max3_f32 v10, v10, v205, v206
    v_max3_f32 v10, v10, v207, v208
    v_max3_f32 v10, v10, v209, v210
    v_max3_f32 v10, v10, v211, v212
    v_max3_f32 v10, v10, v213, v214
    v_max3_f32 v10, v10, v215, v216
    v_max3_f32 v10, v10, v217, v218
    v_max3_f32 v10, v10, v219, v220
    v_max3_f32 v10, v10, v221, v222
    v_max_f32 v10, v10, v223
    v_mov_b32 v11, v10
    s_nop 1
    v_permlane16_swap_b32 v10, v11
    v_max_f32 v10, v10, v11
    v_mov_b32 v11, v10
    s_nop 1
    v_permlane32_swap_b32 v10, v11
    v_max_f32 v10, v10, v11
    v_mul_f32 v12, s13, v10
    v_fma_f32 v192, v192, s13, -v12
    v_fma_f32 v193, v193, s13, -v12
    v_fma_f32 v194, v194, s13, -v12
    v_fma_f32 v195, v195, s13, -v12
    v_fma_f32 v196, v196, s13, -v12
    v_fma_f32 v197, v197, s13, -v12
    v_fma_f32 v198, v198, s13, -v12
    v_fma_f32 v199, v199, s13, -v12
    v_fma_f32 v200, v200, s13, -v12
    v_fma_f32 v201, v201, s13, -v12
    v_fma_f32 v202, v202, s13, -v12
    v_fma_f32 v203, v203, s13, -v12
    v_fma_f32 v204, v204, s13, -v12
    v_fma_f32 v205, v205, s13, -v12
    v_fma_f32 v206, v206, s13, -v12
    v_fma_f32 v207, v207, s13, -v12
    v_fma_f32 v208, v208, s13, -v12
    v_fma_f32 v209, v209, s13, -v12
    v_fma_f32 v210, v210, s13, -v12
    v_fma_f32 v211, v211, s13, -v12
    v_fma_f32 v212, v212, s13, -v12
    v_fma_f32 v213, v213, s13, -v12
    v_fma_f32 v214, v214, s13, -v12
    v_fma_f32 v215, v215, s13, -v12
    v_fma_f32 v216, v216, s13, -v12
    v_fma_f32 v217, v217, s13, -v12
    v_fma_f32 v218, v218, s13, -v12
    v_fma_f32 v219, v219, s13, -v12
    v_fma_f32 v220, v220, s13, -v12
    v_fma_f32 v221, v221, s13, -v12
    v_fma_f32 v222, v222, s13, -v12
    v_fma_f32 v223, v223, s13, -v12
    v_exp_f32 v192, v192
    v_exp_f32 v193, v193
    v_exp_f32 v194, v194
    v_exp_f32 v195, v195
    v_exp_f32 v196, v196
    v_exp_f32 v197, v197
    v_exp_f32 v198, v198
    v_exp_f32 v199, v199
    v_exp_f32 v200, v200
    v_exp_f32 v201, v201
    v_exp_f32 v202, v202
    v_exp_f32 v203, v203
    v_exp_f32 v204, v204
    v_exp_f32 v205, v205
    v_exp_f32 v206, v206
    v_exp_f32 v207, v207
    v_exp_f32 v208, v208
    v_exp_f32 v209, v209
    v_exp_f32 v210, v210
    v_exp_f32 v211, v211
    v_exp_f32 v212, v212
    v_exp_f32 v213, v213
    v_exp_f32 v214, v214
    v_exp_f32 v215, v215
    v_exp_f32 v216, v216
    v_exp_f32 v217, v217
    v_exp_f32 v218, v218
    v_exp_f32 v219, v219
    v_exp_f32 v220, v220
    v_exp_f32 v221, v221
    v_exp_f32 v222, v222
    v_exp_f32 v223, v223
    v_cvt_pk_bf16_f32 v224, v192, v193
    v_cvt_pk_bf16_f32 v225, v194, v195
    v_cvt_pk_bf16_f32 v226, v196, v197
    v_cvt_pk_bf16_f32 v227, v198, v199
    v_cvt_pk_bf16_f32 v228, v200, v201
    v_cvt_pk_bf16_f32 v229, v202, v203
    v_cvt_pk_bf16_f32 v230, v204, v205
    v_cvt_pk_bf16_f32 v231, v206, v207
    v_cvt_pk_bf16_f32 v232, v208, v209
    v_cvt_pk_bf16_f32 v233, v210, v211
    v_cvt_pk_bf16_f32 v234, v212, v213
    v_cvt_pk_bf16_f32 v235, v214, v215
    v_cvt_pk_bf16_f32 v236, v216, v217
    v_cvt_pk_bf16_f32 v237, v218, v219
    v_cvt_pk_bf16_f32 v238, v220, v221
    v_cvt_pk_bf16_f32 v239, v222, v223
    v_lshlrev_b32 v9, 4, v2
    s_lshl_b32 s14, s3, 12
    s_add_u32 s14, s14, 131072
    v_add_u32 v9, s14, v9
    ds_write_b128 v9, v[224:227] offset:0
    ds_write_b128 v9, v[228:231] offset:1024
    ds_write_b128 v9, v[232:235] offset:2048
    ds_write_b128 v9, v[236:239] offset:3072
    v_add_f32 v10, v192, v193
    v_add_f32 v11, v194, v195
    v_add_f32 v10, v10, v196
    v_add_f32 v11, v11, v197
    v_add_f32 v10, v10, v198
    v_add_f32 v11, v11, v199
    v_add_f32 v10, v10, v200
    v_add_f32 v11, v11, v201
    v_add_f32 v10, v10, v202
    v_add_f32 v11, v11, v203
    v_add_f32 v10, v10, v204
    v_add_f32 v11, v11, v205
    v_add_f32 v10, v10, v206
    v_add_f32 v11, v11, v207
    v_add_f32 v10, v10, v208
    v_add_f32 v11, v11, v209
    v_add_f32 v10, v10, v210
    v_add_f32 v11, v11, v211
    v_add_f32 v10, v10, v212
    v_add_f32 v11, v11, v213
    v_add_f32 v10, v10, v214
    v_add_f32 v11, v11, v215
    v_add_f32 v10, v10, v216
    v_add_f32 v11, v11, v217
    v_add_f32 v10, v10, v218
    v_add_f32 v11, v11, v219
    v_add_f32 v10, v10, v220
    v_add_f32 v11, v11, v221
    v_add_f32 v10, v10, v222
    v_add_f32 v11, v11, v223
    s_waitcnt lgkmcnt(0)
    s_mov_b64 exec, 1
    ds_add_u32 v7, v6 offset:20
    s_mov_b64 exec, -1
    v_add_f32 v10, v10, v11
    v_mov_b32 v11, v10
    s_nop 1
    v_permlane16_swap_b32 v10, v11
    v_add_f32 v10, v10, v11
    v_mov_b32 v11, v10
    s_nop 1
    v_permlane32_swap_b32 v10, v11
    v_add_f32 v13, v10, v11
    v_mov_b32 v14, v8
    v_mov_b32 v15, v8
    s_lshl_b32 s43, s41, 10
    s_lshl_b32 s14, s3, 8
    s_add_u32 s43, s43, s14
    s_add_u32 s43, s43, 2097152
    v_lshlrev_b32 v9, 4, v4
    s_mov_b64 exec, 0xffff
    s_cmp_eq_u32 s58, 1
    s_cbranch_scc1 Ls7_f
    buffer_store_dwordx4 v[12:15], v9, s[32:35], s43 offen sc1
    s_branch Ls7_d
Ls7_f:
    buffer_store_dwordx4 v[12:15], v9, s[32:35], s43 offen
Ls7_d:
    s_mov_b64 exec, -1
    s_and_b32 s43, s41, 0xfffffffe
    s_lshl_b32 s43, s43, 10
    s_add_u32 s43, s43, 2097152
    v_lshl_add_u32 v9, v3, 9, v9
    s_mov_b32 s45, 0
L_A_sretry:
    buffer_load_dwordx4 v[240:243], v9, s[32:35], s43 offen sc1
    buffer_load_dwordx4 v[244:247], v9, s[32:35], s43 offen offset:256 sc1
    s_waitcnt vmcnt(0)
    v_xor_b32 v10, v242, v8
    v_xor_b32 v11, v243, v8
    v_or_b32 v10, v10, v11
    v_xor_b32 v11, v246, v8
    v_or_b32 v10, v10, v11
    v_xor_b32 v11, v247, v8
    v_or_b32 v10, v10, v11
    v_cmp_ne_u32 vcc, 0, v10
    s_add_u32 s45, s45, 1
    s_cmp_gt_u32 s45, 30000
    s_cbranch_scc1 L_A_sok
    s_cbranch_vccnz L_A_sretry
L_A_sok:
    v_max_f32 v10, v240, v244
    v_mov_b32 v11, v10
    s_nop 1
    v_permlane16_swap_b32 v10, v11
    v_max_f32 v10, v10, v11
    v_mov_b32 v11, v10
    s_nop 1
    v_permlane32_swap_b32 v10, v11
    v_max_f32 v10, v10, v11
    v_sub_f32 v240, v240, v10
    v_sub_f32 v244, v244, v10
    v_exp_f32 v240, v240
    v_exp_f32 v244, v244
    v_mul_f32 v241, v241, v240
    v_fmac_f32 v241, v245, v244
    v_mov_b32 v11, v241
    s_nop 1
    v_permlane16_swap_b32 v241, v11
    v_add_f32 v241, v241, v11
    v_mov_b32 v11, v241
    s_nop 1
    v_permlane32_swap_b32 v241, v11
    v_add_f32 v11, v241, v11
    v_sub_f32 v12, v12, v10
    v_exp_f32 v12, v12
    v_rcp_f32 v11, v11
    s_nop 0
    v_mul_f32 v12, v12, v11
    v_lshlrev_b32 v9, 2, v4
    s_lshl_b32 s14, s3, 6
    s_add_u32 s14, s14, 147520
    v_add_u32 v9, s14, v9
    ds_write_b32 v9, v12
    s_waitcnt lgkmcnt(0)
    s_mov_b64 exec, 1
    ds_add_u32 v1, v6 offset:36
    s_mov_b64 exec, -1
    s_mov_b32 s15, 0
Lw8:
    ds_read_b32 v10, v1 offset:8
    s_add_u32 s15, s15, 1
    s_waitcnt lgkmcnt(0)
    v_readfirstlane_b32 s14, v10
    s_cmp_gt_u32 s15, 480000
    s_cbranch_scc1 Lw8_o
    s_cmp_ge_u32 s14, 4
    s_cbranch_scc0 Lw8
Lw8_o:
    buffer_load_dwordx2 v[32:33], v16, s[48:51], s46 offen offset:0
    buffer_load_dwordx2 v[34:35], v16, s[48:51], s46 offen offset:1024
    buffer_load_dwordx2 v[36:37], v16, s[48:51], s46 offen offset:2048
    buffer_load_dwordx2 v[38:39], v16, s[48:51], s46 offen offset:3072
    s_add_u32 s46, s46, 4096
    buffer_load_dwordx2 v[40:41], v16, s[48:51], s46 offen offset:0
    buffer_load_dwordx2 v[42:43], v16, s[48:51], s46 offen offset:1024
    buffer_load_dwordx2 v[44:45], v16, s[48:51], s46 offen offset:2048
    buffer_load_dwordx2 v[46:47], v16, s[48:51], s46 offen offset:3072
    s_add_u32 s46, s46, 4096
    buffer_load_dwordx2 v[48:49], v16, s[48:51], s46 offen offset:0
    buffer_load_dwordx2 v[50:51], v16, s[48:51], s46 offen offset:1024
    buffer_load_dwordx2 v[52:53], v16, s[48:51], s46 offen offset:2048
    buffer_load_dwordx2 v[54:55], v16, s[48:51], s46 offen offset:3072
    s_add_u32 s46, s46, 4096
    buffer_load_dwordx2 v[56:57], v16, s[48:51], s46 offen offset:0
    buffer_load_dwordx2 v[58:59], v16, s[48:51], s46 offen offset:1024
    buffer_load_dwordx2 v[60:61], v16, s[48:51], s46 offen offset:2048
    buffer_load_dwordx2 v[62:63], v16, s[48:51], s46 offen offset:3072
    s_add_u32 s46, s46, 4096
    buffer_load_dwordx2 v[64:65], v16, s[48:51], s46 offen offset:0
    buffer_load_dwordx2 v[66:67], v16, s[48:51], s46 offen offset:1024
    buffer_load_dwordx2 v[68:69], v16, s[48:51], s46 offen offset:2048
    buffer_load_dwordx2 v[70:71], v16, s[48:51], s46 offen offset:3072
    s_add_u32 s46, s46, 4096
    buffer_load_dwordx2 v[72:73], v16, s[48:51], s46 offen offset:0
    buffer_load_dwordx2 v[74:75], v16, s[48:51], s46 offen offset:1024
    buffer_load_dwordx2 v[76:77], v16, s[48:51], s46 offen offset:2048
    buffer_load_dwordx2 v[78:79], v16, s[48:51], s46 offen offset:3072
    s_add_u32 s46, s46, 4096
    buffer_load_dwordx2 v[80:81], v16, s[48:51], s46 offen offset:0
    buffer_load_dwordx2 v[82:83], v16, s[48:51], s46 offen offset:1024
    buffer_load_dwordx2 v[84:85], v16, s[48:51], s46 offen offset:2048
    buffer_load_dwordx2 v[86:87], v16, s[48:51], s46 offen offset:3072
    s_add_u32 s46, s46, 4096
    buffer_load_dwordx2 v[88:89], v16, s[48:51], s46 offen offset:0
    buffer_load_dwordx2 v[90:91], v16, s[48:51], s46 offen offset:1024
    buffer_load_dwordx2 v[92:93], v16, s[48:51], s46 offen offset:2048
    buffer_load_dwordx2 v[94:95], v16, s[48:51], s46 offen offset:3072
    v_add_u32 v10, s3, v4
    v_and_b32 v10, 3, v10
    v_lshrrev_b32 v9, 2, v4
    v_lshlrev_b32 v9, 13, v9
    v_lshl_add_u32 v9, v10, 6, v9
    v_lshl_add_u32 v9, v3, 4, v9
    s_lshl_b32 s43, s42, 12
    s_lshl_b32 s14, s3, 10
    s_add_u32 s43, s43, s14
    s_add_u32 s43, s43, 3145728
    s_add_u32 s44, s43, 4096
    s_lshl_b32 s46, s42, 4
    s_add_u32 s46, s46, 36864
    v_lshlrev_b32 v7, 2, v2
    s_add_u32 s14, s3, 1
    s_and_b32 s14, s14, 3
    s_lshl_b32 s14, s14, 12
    s_add_u32 s14, s14, 32768
    v_add_u32 v13, s14, v7
    s_add_u32 s14, s3, 2
    s_and_b32 s14, s14, 3
    s_lshl_b32 s14, s14, 12
    s_add_u32 s14, s14, 33792
    v_add_u32 v14, s14, v7
    s_add_u32 s14, s3, 3
    s_and_b32 s14, s14, 3
    s_lshl_b32 s14, s14, 12
    s_add_u32 s14, s14, 34816
    v_add_u32 v15, s14, v7
    s_lshl_b32 s14, s3, 12
    s_add_u32 s14, s14, 32768
    v_add_u32 v12, s14, v7
    v_lshlrev_b32 v17, 10, v3
    v_lshl_add_u32 v17, v4, 4, v17
    s_lshl_b32 s47, s41, 12
    s_lshl_b32 s14, s3, 8
    s_add_u32 s47, s47, s14
    s_add_u32 s47, s47, 5242880
    s_mov_b32 s60, 0x7060500
    s_mov_b32 s61, 0x7060501
    s_mov_b32 s62, 0x7060502
    s_mov_b32 s63, 0x7060503
    s_waitcnt vmcnt(24)
    v_perm_b32 v96, v34, v32, s11
    v_perm_b32 v97, v38, v36, s11
    v_perm_b32 v98, v42, v40, s11
    v_perm_b32 v99, v46, v44, s11
    v_perm_b32 v100, v34, v32, s12
    v_perm_b32 v101, v38, v36, s12
    v_perm_b32 v102, v42, v40, s12
    v_perm_b32 v103, v46, v44, s12
    v_perm_b32 v104, v35, v33, s11
    v_perm_b32 v105, v39, v37, s11
    v_perm_b32 v106, v43, v41, s11
    v_perm_b32 v107, v47, v45, s11
    v_perm_b32 v108, v35, v33, s12
    v_perm_b32 v109, v39, v37, s12
    v_perm_b32 v110, v43, v41, s12
    v_perm_b32 v111, v47, v45, s12
    s_waitcnt vmcnt(16)
    v_perm_b32 v112, v50, v48, s11
    v_perm_b32 v113, v54, v52, s11
    v_perm_b32 v114, v58, v56, s11
    v_perm_b32 v115, v62, v60, s11
    v_perm_b32 v116, v50, v48, s12
    v_perm_b32 v117, v54, v52, s12
    v_perm_b32 v118, v58, v56, s12
    v_perm_b32 v119, v62, v60, s12
    v_perm_b32 v120, v51, v49, s11
    v_perm_b32 v121, v55, v53, s11
    v_perm_b32 v122, v59, v57, s11
    v_perm_b32 v123, v63, v61, s11
    v_perm_b32 v124, v51, v49, s12
    v_perm_b32 v125, v55, v53, s12
    v_perm_b32 v126, v59, v57, s12
    v_perm_b32 v127, v63, v61, s12
    s_waitcnt vmcnt(8)
    v_perm_b32 v128, v66, v64, s11
    v_perm_b32 v129, v70, v68, s11
    v_perm_b32 v130, v74, v72, s11
    v_perm_b32 v131, v78, v76, s11
    v_perm_b32 v132, v66, v64, s12
    v_perm_b32 v133, v70, v68, s12
    v_perm_b32 v134, v74, v72, s12
    v_perm_b32 v135, v78, v76, s12
    v_perm_b32 v136, v67, v65, s11
    v_perm_b32 v137, v71, v69, s11
    v_perm_b32 v138, v75, v73, s11
    v_perm_b32 v139, v79, v77, s11
    v_perm_b32 v140, v67, v65, s12
    v_perm_b32 v141, v71, v69, s12
    v_perm_b32 v142, v75, v73, s12
    v_perm_b32 v143, v79, v77, s12
    s_waitcnt vmcnt(0)
    v_perm_b32 v144, v82, v80, s11
    v_perm_b32 v145, v86, v84, s11
    v_perm_b32 v146, v90, v88, s11
    v_perm_b32 v147, v94, v92, s11
    v_perm_b32 v148, v82, v80, s12
    v_perm_b32 v149, v86, v84, s12
    v_perm_b32 v150, v90, v88, s12
    v_perm_b32 v151, v94, v92, s12
    v_perm_b32 v152, v83, v81, s11
    v_perm_b32 v153, v87, v85, s11
    v_perm_b32 v154, v91, v89, s11
    v_perm_b32 v155, v95, v93, s11
    v_perm_b32 v156, v83, v81, s12
    v_perm_b32 v157, v87, v85, s12
    v_perm_b32 v158, v91, v89, s12
    v_perm_b32 v159, v95, v93, s12
    s_mov_b32 s45, 0
L_A_fretry:
    s_mov_b32 exec_hi, 0
    buffer_load_dword v10, v7, s[32:35], s46 offen sc1
    s_waitcnt vmcnt(0)
    v_cmp_ne_u32 vcc, v10, v8
    s_mov_b64 exec, -1
    s_add_u32 s45, s45, 1
    s_cmp_gt_u32 s45, 30000
    s_cbranch_scc1 L_A_fok
    s_cbranch_vccnz L_A_fretry
L_A_fok:
    s_mov_b32 s45, 0
    s_cmp_eq_u32 s58, 1
    s_cbranch_scc0 L_A_oretry
    buffer_load_dwordx4 v[192:195], v9, s[32:35], s43 offen offset:0
    buffer_load_dwordx4 v[196:199], v9, s[32:35], s43 offen offset:256
    buffer_load_dwordx4 v[200:203], v9, s[32:35], s43 offen offset:512
    buffer_load_dwordx4 v[204:207], v9, s[32:35], s43 offen offset:768
    buffer_load_dwordx4 v[208:211], v9, s[32:35], s44 offen offset:0
    buffer_load_dwordx4 v[212:215], v9, s[32:35], s44 offen offset:256
    buffer_load_dwordx4 v[216:219], v9, s[32:35], s44 offen offset:512
    buffer_load_dwordx4 v[220:223], v9, s[32:35], s44 offen offset:768
    s_branch L_A_ogo
L_A_oretry:
    buffer_load_dwordx4 v[192:195], v9, s[32:35], s43 offen offset:0 sc1
    buffer_load_dwordx4 v[196:199], v9, s[32:35], s43 offen offset:256 sc1
    buffer_load_dwordx4 v[200:203], v9, s[32:35], s43 offen offset:512 sc1
    buffer_load_dwordx4 v[204:207], v9, s[32:35], s43 offen offset:768 sc1
    buffer_load_dwordx4 v[208:211], v9, s[32:35], s44 offen offset:0 sc1
    buffer_load_dwordx4 v[212:215], v9, s[32:35], s44 offen offset:256 sc1
    buffer_load_dwordx4 v[216:219], v9, s[32:35], s44 offen offset:512 sc1
    buffer_load_dwordx4 v[220:223], v9, s[32:35], s44 offen offset:768 sc1
L_A_ogo:
    s_waitcnt vmcnt(7)
    v_mfma_f32_16x16x32_bf16 v[176:179], v[192:195], v[96:99], 0
    v_mfma_f32_16x16x32_bf16 v[180:183], v[192:195], v[100:103], 0
    v_mfma_f32_16x16x32_bf16 v[184:187], v[192:195], v[104:107], 0
    v_mfma_f32_16x16x32_bf16 v[188:191], v[192:195], v[108:111], 0
    v_max3_u32 v10, v192, v193, v194
    v_max_u32 v10, v10, v195
    s_waitcnt vmcnt(6)
    v_mfma_f32_16x16x32_bf16 v[176:179], v[196:199], v[112:115], v[176:179]
    v_mfma_f32_16x16x32_bf16 v[180:183], v[196:199], v[116:119], v[180:183]
    v_mfma_f32_16x16x32_bf16 v[184:187], v[196:199], v[120:123], v[184:187]
    v_mfma_f32_16x16x32_bf16 v[188:191], v[196:199], v[124:127], v[188:191]
    v_max3_u32 v10, v10, v196, v197
    v_max3_u32 v10, v10, v198, v199
    s_waitcnt vmcnt(5)
    v_mfma_f32_16x16x32_bf16 v[176:179], v[200:203], v[128:131], v[176:179]
    v_mfma_f32_16x16x32_bf16 v[180:183], v[200:203], v[132:135], v[180:183]
    v_mfma_f32_16x16x32_bf16 v[184:187], v[200:203], v[136:139], v[184:187]
    v_mfma_f32_16x16x32_bf16 v[188:191], v[200:203], v[140:143], v[188:191]
    v_max3_u32 v10, v10, v200, v201
    v_max3_u32 v10, v10, v202, v203
    s_waitcnt vmcnt(4)
    v_mfma_f32_16x16x32_bf16 v[176:179], v[204:207], v[144:147], v[176:179]
    v_mfma_f32_16x16x32_bf16 v[180:183], v[204:207], v[148:151], v[180:183]
    v_mfma_f32_16x16x32_bf16 v[184:187], v[204:207], v[152:155], v[184:187]
    v_mfma_f32_16x16x32_bf16 v[188:191], v[204:207], v[156:159], v[188:191]
    v_max3_u32 v10, v10, v204, v205
    v_max3_u32 v10, v10, v206, v207
    s_waitcnt vmcnt(3)
    v_mfma_f32_16x16x32_bf16 v[176:179], v[208:211], v[96:99], v[176:179]
    v_mfma_f32_16x16x32_bf16 v[180:183], v[208:211], v[100:103], v[180:183]
    v_mfma_f32_16x16x32_bf16 v[184:187], v[208:211], v[104:107], v[184:187]
    v_mfma_f32_16x16x32_bf16 v[188:191], v[208:211], v[108:111], v[188:191]
    v_max3_u32 v10, v10, v208, v209
    v_max3_u32 v10, v10, v210, v211
    s_waitcnt vmcnt(2)
    v_mfma_f32_16x16x32_bf16 v[176:179], v[212:215], v[112:115], v[176:179]
    v_mfma_f32_16x16x32_bf16 v[180:183], v[212:215], v[116:119], v[180:183]
    v_mfma_f32_16x16x32_bf16 v[184:187], v[212:215], v[120:123], v[184:187]
    v_mfma_f32_16x16x32_bf16 v[188:191], v[212:215], v[124:127], v[188:191]
    v_max3_u32 v10, v10, v212, v213
    v_max3_u32 v10, v10, v214, v215
    s_waitcnt vmcnt(1)
    v_mfma_f32_16x16x32_bf16 v[176:179], v[216:219], v[128:131], v[176:179]
    v_mfma_f32_16x16x32_bf16 v[180:183], v[216:219], v[132:135], v[180:183]
    v_mfma_f32_16x16x32_bf16 v[184:187], v[216:219], v[136:139], v[184:187]
    v_mfma_f32_16x16x32_bf16 v[188:191], v[216:219], v[140:143], v[188:191]
    v_max3_u32 v10, v10, v216, v217
    v_max3_u32 v10, v10, v218, v219
    s_waitcnt vmcnt(0)
    v_mfma_f32_16x16x32_bf16 v[176:179], v[220:223], v[144:147], v[176:179]
    v_mfma_f32_16x16x32_bf16 v[180:183], v[220:223], v[148:151], v[180:183]
    v_mfma_f32_16x16x32_bf16 v[184:187], v[220:223], v[152:155], v[184:187]
    v_mfma_f32_16x16x32_bf16 v[188:191], v[220:223], v[156:159], v[188:191]
    v_max3_u32 v10, v10, v220, v221
    v_max3_u32 v10, v10, v222, v223
    v_cmp_eq_u32 vcc, -1, v10
    s_add_u32 s45, s45, 1
    s_cmp_gt_u32 s45, 30000
    s_cbranch_scc1 L_A_ook
    s_cbranch_vccnz L_A_oretry
L_A_ook:
    ds_write2st64_b32 v13, v177, v181 offset0:0 offset1:1
    ds_write2st64_b32 v13, v185, v189 offset0:2 offset1:3
    ds_write2st64_b32 v14, v178, v182 offset0:0 offset1:1
    ds_write2st64_b32 v14, v186, v190 offset0:2 offset1:3
    ds_write2st64_b32 v15, v179, v183 offset0:0 offset1:1
    ds_write2st64_b32 v15, v187, v191 offset0:2 offset1:3
    s_waitcnt lgkmcnt(0)
    s_barrier
    ds_read2st64_b32 v[20:21], v12 offset0:0 offset1:1
    ds_read2st64_b32 v[22:23], v12 offset0:2 offset1:3
    ds_read2st64_b32 v[24:25], v12 offset0:4 offset1:5
    ds_read2st64_b32 v[26:27], v12 offset0:6 offset1:7
    ds_read2st64_b32 v[28:29], v12 offset0:8 offset1:9
    ds_read2st64_b32 v[30:31], v12 offset0:10 offset1:11
    s_waitcnt lgkmcnt(0)
    v_add_f32 v20, v20, v24
    v_add_f32 v28, v28, v176
    v_add_f32 v21, v21, v25
    v_add_f32 v29, v29, v180
    v_add_f32 v22, v22, v26
    v_add_f32 v30, v30, v184
    v_add_f32 v23, v23, v27
    v_add_f32 v31, v31, v188
    v_add_f32 v20, v20, v28
    v_add_f32 v21, v21, v29
    v_add_f32 v22, v22, v30
    v_add_f32 v23, v23, v31
    v_perm_b32 v32, v20, v8, s60
    v_perm_b32 v33, v21, v8, s61
    v_perm_b32 v34, v22, v8, s62
    v_perm_b32 v35, v23, v8, s63
    buffer_store_dwordx4 v[32:35], v17, s[32:35], s47 offen sc1
    s_branch L_end
L_B:
    s_sub_u32 s3, s3, 4
    s_lshr_b32 s14, s5, 1
    s_lshl_b32 s14, s14, 3
    s_add_u32 s14, s14, s4
    s_lshl_b32 s14, s14, 12
    s_lshl_b32 s15, s9, 9
    s_add_u32 s14, s14, s15
    s_lshl_b32 s15, s3, 7
    s_add_u32 s14, s14, s15
    s_add_u32 s14, s14, 3072
    s_lshl_b32 s14, s14, 8
    s_mov_b32 s57, s14
    s_lshl_b32 s56, s3, 1
    s_add_u32 s56, s56, s5
    s_and_b32 s56, s56, 7
    s_lshl_b32 s56, s56, 12
    v_add_u32 v10, 0, v3
    v_xor_b32 v10, v10, v4
    v_lshlrev_b32 v10, 4, v10
    v_lshl_add_u32 v12, v3, 8, v10
    v_add_u32 v10, 4, v3
    v_xor_b32 v10, v10, v4
    v_lshlrev_b32 v10, 4, v10
    v_lshl_add_u32 v13, v3, 8, v10
    v_add_u32 v10, 8, v3
    v_xor_b32 v10, v10, v4
    v_lshlrev_b32 v10, 4, v10
    v_lshl_add_u32 v14, v3, 8, v10
    v_add_u32 v10, 12, v3
    v_xor_b32 v10, v10, v4
    v_lshlrev_b32 v10, 4, v10
    v_lshl_add_u32 v15, v3, 8, v10
    s_lshl_b32 s47, s3, 15
    s_lshl_b32 s15, s6, 7
    s_waitcnt lgkmcnt(0)
    s_add_u32 s48, s18, s57
    s_addc_u32 s49, s19, 0
    s_mov_b32 s50, 32768
    s_mov_b32 s51, 0x20000
    s_load_dword s10, s[30:31], s15
    s_add_u32 s36, s20, s57
    s_addc_u32 s37, s21, 0
    s_mov_b32 s38, 32768
    s_mov_b32 s39, 0x20000
    s_mov_b32 s32, s30
    s_mov_b32 s33, s31
    s_mov_b32 s34, 8388608
    s_mov_b32 s35, 0x20000
    s_cmp_eq_u32 s7, 3
    s_cselect_b64 vcc, -1, 0
    s_add_u32 s14, s47, 0
    s_mov_b32 m0, s14
    s_xor_b32 s14, s56, 0
    buffer_load_dwordx4 v12, s[48:51], s14 offen offset:0 nt lds
    buffer_load_dwordx4 v13, s[48:51], s14 offen offset:1024 nt lds
    buffer_load_dwordx4 v14, s[48:51], s14 offen offset:2048 nt lds
    buffer_load_dwordx4 v15, s[48:51], s14 offen offset:3072 nt lds
    s_barrier
    v_add_u32 v7, s3, v4
    v_and_b32 v7, 3, v7
    v_and_b32 v10, 12, v4
    v_or_b32 v7, v7, v10
    v_lshlrev_b32 v7, 4, v7
    v_lshl_add_u32 v7, v3, 10, v7
    s_lshl_b32 s15, s3, 2
    v_add_u32 v11, s15, v1
    s_add_u32 s14, s47, 4096
    s_mov_b32 m0, s14
    s_xor_b32 s14, s56, 4096
    buffer_load_dwordx4 v12, s[48:51], s14 offen offset:0 nt lds
    s_cbranch_vccnz Lt9
    s_waitcnt vmcnt(4)
Lt9:
    buffer_load_dwordx4 v13, s[48:51], s14 offen offset:1024 nt lds
    s_cbranch_vccnz Lt10
    s_waitcnt vmcnt(4)
Lt10:
    buffer_load_dwordx4 v14, s[48:51], s14 offen offset:2048 nt lds
    s_cbranch_vccnz Lt11
    s_waitcnt vmcnt(4)
Lt11:
    buffer_load_dwordx4 v15, s[48:51], s14 offen offset:3072 nt lds
    s_add_u32 s14, s47, 8192
    s_mov_b32 m0, s14
    s_xor_b32 s14, s56, 8192
    s_cbranch_vccnz Lt12
    s_waitcnt vmcnt(4)
Lt12:
    buffer_load_dwordx4 v12, s[48:51], s14 offen offset:0 nt lds
    s_cbranch_vccnz Lt13
    s_waitcnt vmcnt(4)
Lt13:
    buffer_load_dwordx4 v13, s[48:51], s14 offen offset:1024 nt lds
    s_waitcnt vmcnt(9)
    s_cbranch_vccnz Lt14
    s_waitcnt vmcnt(4)
Lt14:
    buffer_load_dwordx4 v14, s[48:51], s14 offen offset:2048 nt lds
    s_waitcnt vmcnt(9)
    s_cbranch_vccnz Lt15
    s_waitcnt vmcnt(4)
Lt15:
    buffer_load_dwordx4 v15, s[48:51], s14 offen offset:3072 nt lds
    s_add_u32 s14, s47, 12288
    s_mov_b32 m0, s14
    s_xor_b32 s14, s56, 12288
    s_waitcnt vmcnt(9)
    s_cbranch_vccnz Lt16
    s_waitcnt vmcnt(4)
Lt16:
    buffer_load_dwordx4 v12, s[48:51], s14 offen offset:0 nt lds
    s_waitcnt vmcnt(9)
    s_cbranch_vccnz Lt17
    s_waitcnt vmcnt(4)
Lt17:
    buffer_load_dwordx4 v13, s[48:51], s14 offen offset:1024 nt lds
    s_waitcnt vmcnt(9)
    s_cbranch_vccnz Lt18
    s_waitcnt vmcnt(4)
Lt18:
    buffer_load_dwordx4 v14, s[48:51], s14 offen offset:2048 nt lds
    s_waitcnt vmcnt(9)
    s_cbranch_vccnz Lt19
    s_waitcnt vmcnt(4)
Lt19:
    buffer_load_dwordx4 v15, s[48:51], s14 offen offset:3072 nt lds
    s_add_u32 s14, s47, 16384
    s_mov_b32 m0, s14
    s_xor_b32 s14, s56, 16384
    s_waitcnt vmcnt(9)
    s_cbranch_vccnz Lt20
    s_waitcnt vmcnt(4)
Lt20:
    buffer_load_dwordx4 v12, s[48:51], s14 offen offset:0 nt lds
    s_waitcnt vmcnt(9)
    s_cbranch_vccnz Lt21
    s_waitcnt vmcnt(4)
Lt21:
    buffer_load_dwordx4 v13, s[48:51], s14 offen offset:1024 nt lds
    s_waitcnt vmcnt(9)
    s_cbranch_vccnz Lt22
    s_waitcnt vmcnt(4)
Lt22:
    buffer_load_dwordx4 v14, s[48:51], s14 offen offset:2048 nt lds
    s_waitcnt vmcnt(9)
    s_cbranch_vccnz Lt23
    s_waitcnt vmcnt(4)
Lt23:
    buffer_load_dwordx4 v15, s[48:51], s14 offen offset:3072 nt lds
    s_add_u32 s14, s47, 20480
    s_mov_b32 m0, s14
    s_xor_b32 s14, s56, 20480
    s_waitcnt vmcnt(9)
    s_cbranch_vccnz Lt24
    s_waitcnt vmcnt(4)
Lt24:
    buffer_load_dwordx4 v12, s[48:51], s14 offen offset:0 nt lds
    s_waitcnt vmcnt(9)
    s_cbranch_vccnz Lt25
    s_waitcnt vmcnt(4)
Lt25:
    buffer_load_dwordx4 v13, s[48:51], s14 offen offset:1024 nt lds
    s_waitcnt vmcnt(9)
    s_cbranch_vccnz Lt26
    s_waitcnt vmcnt(4)
Lt26:
    buffer_load_dwordx4 v14, s[48:51], s14 offen offset:2048 nt lds
    s_waitcnt vmcnt(9)
    s_cbranch_vccnz Lt27
    s_waitcnt vmcnt(4)
Lt27:
    buffer_load_dwordx4 v15, s[48:51], s14 offen offset:3072 nt lds
    s_add_u32 s14, s47, 24576
    s_mov_b32 m0, s14
    s_xor_b32 s14, s56, 24576
    s_waitcnt vmcnt(9)
    s_cbranch_vccnz Lt28
    s_waitcnt vmcnt(4)
Lt28:
    buffer_load_dwordx4 v12, s[48:51], s14 offen offset:0 nt lds
    s_waitcnt vmcnt(9)
    s_cbranch_vccnz Lt29
    s_waitcnt vmcnt(4)
Lt29:
    buffer_load_dwordx4 v13, s[48:51], s14 offen offset:1024 nt lds
    s_waitcnt vmcnt(9)
    s_cbranch_vccnz Lt30
    s_waitcnt vmcnt(4)
Lt30:
    buffer_load_dwordx4 v14, s[48:51], s14 offen offset:2048 nt lds
    s_waitcnt vmcnt(9)
    s_cbranch_vccnz Lt31
    s_waitcnt vmcnt(4)
Lt31:
    buffer_load_dwordx4 v15, s[48:51], s14 offen offset:3072 nt lds
    s_add_u32 s14, s47, 28672
    s_mov_b32 m0, s14
    s_xor_b32 s14, s56, 28672
    s_waitcnt vmcnt(9)
    s_cbranch_vccnz Lt32
    s_waitcnt vmcnt(4)
Lt32:
    buffer_load_dwordx4 v12, s[48:51], s14 offen offset:0 nt lds
    s_waitcnt vmcnt(9)
    s_cbranch_vccnz Lt33
    s_waitcnt vmcnt(4)
Lt33:
    buffer_load_dwordx4 v13, s[48:51], s14 offen offset:1024 nt lds
    s_waitcnt vmcnt(9)
    s_cbranch_vccnz Lt34
    s_waitcnt vmcnt(4)
Lt34:
    buffer_load_dwordx4 v14, s[48:51], s14 offen offset:2048 nt lds
    s_waitcnt vmcnt(9)
    s_cbranch_vccnz Lt35
    s_waitcnt vmcnt(4)
Lt35:
    buffer_load_dwordx4 v15, s[48:51], s14 offen offset:3072 nt lds
    s_xor_b32 s14, s56, 0
    s_waitcnt vmcnt(9)
    s_cbranch_vccnz Lt36
    s_waitcnt vmcnt(4)
Lt36:
    buffer_load_dwordx4 v[16:19], v7, s[36:39], s14 offen offset:0 nt
    s_waitcnt vmcnt(9)
    s_cbranch_vccnz Lt37
    s_waitcnt vmcnt(4)
Lt37:
    buffer_load_dwordx4 v[20:23], v7, s[36:39], s14 offen offset:256 nt
    s_waitcnt vmcnt(9)
    s_cbranch_vccnz Lt38
    s_waitcnt vmcnt(4)
Lt38:
    buffer_load_dwordx4 v[24:27], v7, s[36:39], s14 offen offset:512 nt
    s_waitcnt vmcnt(9)
    s_cbranch_vccnz Lt39
    s_waitcnt vmcnt(4)
Lt39:
    buffer_load_dwordx4 v[28:31], v7, s[36:39], s14 offen offset:768 nt
    s_xor_b32 s14, s56, 4096
    s_waitcnt vmcnt(9)
    s_cbranch_vccnz Lt40
    s_waitcnt vmcnt(4)
Lt40:
    s_cbranch_vccnz Lk41
    s_mov_b64 exec, 1
    ds_add_u32 v11, v6 offset:44
    s_mov_b64 exec, -1
Lk41:
    buffer_load_dwordx4 v[32:35], v7, s[36:39], s14 offen offset:0 nt
    s_waitcnt vmcnt(9)
    s_cbranch_vccnz Lt42
    s_waitcnt vmcnt(4)
Lt42:
    buffer_load_dwordx4 v[36:39], v7, s[36:39], s14 offen offset:256 nt
    s_waitcnt vmcnt(9)
    s_cbranch_vccnz Lt43
    s_waitcnt vmcnt(4)
Lt43:
    buffer_load_dwordx4 v[40:43], v7, s[36:39], s14 offen offset:512 nt
    s_waitcnt vmcnt(9)
    s_cbranch_vccnz Lt44
    s_waitcnt vmcnt(4)
Lt44:
    buffer_load_dwordx4 v[44:47], v7, s[36:39], s14 offen offset:768 nt
    s_xor_b32 s14, s56, 8192
    s_waitcnt vmcnt(9)
    s_cbranch_vccnz Lt45
    s_waitcnt vmcnt(4)
Lt45:
    buffer_load_dwordx4 v[48:51], v7, s[36:39], s14 offen offset:0 nt
    s_waitcnt vmcnt(9)
    s_cbranch_vccnz Lt46
    s_waitcnt vmcnt(4)
Lt46:
    s_cbranch_vccz Lk47
    s_mov_b64 exec, 1
    ds_add_u32 v11, v6 offset:44
    s_mov_b64 exec, -1
Lk47:
    buffer_load_dwordx4 v[52:55], v7, s[36:39], s14 offen offset:256 nt
    s_waitcnt vmcnt(9)
    s_cbranch_vccnz Lt48
    s_waitcnt vmcnt(4)
Lt48:
    buffer_load_dwordx4 v[56:59], v7, s[36:39], s14 offen offset:512 nt
    s_waitcnt vmcnt(9)
    s_cbranch_vccnz Lt49
    s_waitcnt vmcnt(4)
Lt49:
    buffer_load_dwordx4 v[60:63], v7, s[36:39], s14 offen offset:768 nt
    s_xor_b32 s14, s56, 12288
    s_waitcnt vmcnt(9)
    s_cbranch_vccnz Lt50
    s_waitcnt vmcnt(4)
Lt50:
    buffer_load_dwordx4 v[64:67], v7, s[36:39], s14 offen offset:0 nt
    s_waitcnt vmcnt(9)
    s_cbranch_vccnz Lt51
    s_waitcnt vmcnt(4)
Lt51:
    buffer_load_dwordx4 v[68:71], v7, s[36:39], s14 offen offset:256 nt
    s_waitcnt vmcnt(9)
    s_cbranch_vccnz Lt52
    s_waitcnt vmcnt(4)
Lt52:
    buffer_load_dwordx4 v[72:75], v7, s[36:39], s14 offen offset:512 nt
    s_waitcnt vmcnt(9)
    s_cbranch_vccnz Lt53
    s_waitcnt vmcnt(4)
Lt53:
    buffer_load_dwordx4 v[76:79], v7, s[36:39], s14 offen offset:768 nt
    s_xor_b32 s14, s56, 16384
    s_waitcnt vmcnt(9)
    s_cbranch_vccnz Lt54
    s_waitcnt vmcnt(7)
Lt54:
    buffer_load_dwordx4 v[80:83], v7, s[36:39], s14 offen offset:0 nt
    s_waitcnt vmcnt(9)
    s_cbranch_vccnz Lt55
    s_waitcnt vmcnt(7)
Lt55:
    buffer_load_dwordx4 v[84:87], v7, s[36:39], s14 offen offset:256 nt
    s_waitcnt vmcnt(9)
    s_cbranch_vccnz Lt56
    s_waitcnt vmcnt(7)
Lt56:
    buffer_load_dwordx4 v[88:91], v7, s[36:39], s14 offen offset:512 nt
    s_waitcnt vmcnt(9)
    s_cbranch_vccnz Lt57
    s_waitcnt vmcnt(7)
Lt57:
    buffer_load_dwordx4 v[92:95], v7, s[36:39], s14 offen offset:768 nt
    s_xor_b32 s14, s56, 20480
    s_waitcnt vmcnt(9)
    s_cbranch_vccnz Lt58
    s_waitcnt vmcnt(7)
Lt58:
    buffer_load_dwordx4 v[96:99], v7, s[36:39], s14 offen offset:0 nt
    s_waitcnt vmcnt(9)
    s_cbranch_vccnz Lt59
    s_waitcnt vmcnt(7)
Lt59:
    buffer_load_dwordx4 v[100:103], v7, s[36:39], s14 offen offset:256 nt
    s_waitcnt vmcnt(9)
    s_cbranch_vccnz Lt60
    s_waitcnt vmcnt(7)
Lt60:
    buffer_load_dwordx4 v[104:107], v7, s[36:39], s14 offen offset:512 nt
    s_waitcnt vmcnt(9)
    s_cbranch_vccnz Lt61
    s_waitcnt vmcnt(7)
Lt61:
    buffer_load_dwordx4 v[108:111], v7, s[36:39], s14 offen offset:768 nt
    s_xor_b32 s14, s56, 24576
    s_waitcnt vmcnt(9)
    s_cbranch_vccnz Lt62
    s_waitcnt vmcnt(7)
Lt62:
    buffer_load_dwordx4 v[112:115], v7, s[36:39], s14 offen offset:0 nt
    s_waitcnt vmcnt(9)
    s_cbranch_vccnz Lt63
    s_waitcnt vmcnt(7)
Lt63:
    buffer_load_dwordx4 v[116:119], v7, s[36:39], s14 offen offset:256 nt
    s_waitcnt vmcnt(9)
    s_cbranch_vccnz Lt64
    s_waitcnt vmcnt(7)
Lt64:
    buffer_load_dwordx4 v[120:123], v7, s[36:39], s14 offen offset:512 nt
    s_waitcnt vmcnt(9)
    s_cbranch_vccnz Lt65
    s_waitcnt vmcnt(7)
Lt65:
    buffer_load_dwordx4 v[124:127], v7, s[36:39], s14 offen offset:768 nt
    s_xor_b32 s14, s56, 28672
    s_waitcnt vmcnt(9)
    s_cbranch_vccnz Lt66
    s_waitcnt vmcnt(7)
Lt66:
    buffer_load_dwordx4 v[128:131], v7, s[36:39], s14 offen offset:0 nt
    s_waitcnt vmcnt(9)
    s_cbranch_vccnz Lt67
    s_waitcnt vmcnt(7)
Lt67:
    buffer_load_dwordx4 v[132:135], v7, s[36:39], s14 offen offset:256 nt
    s_waitcnt vmcnt(9)
    s_cbranch_vccnz Lt68
    s_waitcnt vmcnt(7)
Lt68:
    buffer_load_dwordx4 v[136:139], v7, s[36:39], s14 offen offset:512 nt
    s_waitcnt vmcnt(9)
    s_cbranch_vccnz Lt69
    s_waitcnt vmcnt(7)
Lt69:
    buffer_load_dwordx4 v[140:143], v7, s[36:39], s14 offen offset:768 nt
    s_mov_b64 exec, 1
    ds_add_u32 v1, v6 offset:8
    s_mov_b64 exec, -1
    s_mov_b32 s15, 0
Lw70:
    ds_read_b32 v10, v11 offset:20
    s_add_u32 s15, s15, 1
    s_waitcnt lgkmcnt(0)
    v_readfirstlane_b32 s14, v10
    s_cmp_gt_u32 s15, 480000
    s_cbranch_scc1 Lw70_o
    s_cmp_ge_u32 s14, 1
    s_cbranch_scc0 Lw70
Lw70_o:
    v_lshlrev_b32 v9, 4, v2
    s_lshl_b32 s14, s3, 12
    s_add_u32 s14, s14, 131072
    v_add_u32 v9, s14, v9
    ds_read_b128 v[144:147], v9 offset:0
    ds_read_b128 v[148:151], v9 offset:1024
    ds_read_b128 v[152:155], v9 offset:2048
    ds_read_b128 v[156:159], v9 offset:3072
    ds_read_b32 v10, v1 offset:60
    s_waitcnt lgkmcnt(0)
    s_add_u32 s10, s10, 0x9e3779b9
    v_mov_b32 v8, s10
    v_readfirstlane_b32 s58, v10
    s_setprio 3
    s_waitcnt vmcnt(24)
    v_perm_b32 v160, v20, v16, s11
    v_perm_b32 v161, v28, v24, s11
    v_perm_b32 v162, v36, v32, s11
    v_perm_b32 v163, v44, v40, s11
    v_perm_b32 v164, v20, v16, s12
    v_perm_b32 v165, v28, v24, s12
    v_perm_b32 v166, v36, v32, s12
    v_perm_b32 v167, v44, v40, s12
    v_perm_b32 v168, v21, v17, s11
    v_perm_b32 v169, v29, v25, s11
    v_perm_b32 v170, v37, v33, s11
    v_perm_b32 v171, v45, v41, s11
    v_perm_b32 v172, v21, v17, s12
    v_perm_b32 v173, v29, v25, s12
    v_perm_b32 v174, v37, v33, s12
    v_perm_b32 v175, v45, v41, s12
    v_perm_b32 v176, v22, v18, s11
    v_perm_b32 v177, v30, v26, s11
    v_perm_b32 v178, v38, v34, s11
    v_perm_b32 v179, v46, v42, s11
    v_perm_b32 v180, v22, v18, s12
    v_perm_b32 v181, v30, v26, s12
    v_perm_b32 v182, v38, v34, s12
    v_perm_b32 v183, v46, v42, s12
    v_perm_b32 v184, v23, v19, s11
    v_perm_b32 v185, v31, v27, s11
    v_perm_b32 v186, v39, v35, s11
    v_perm_b32 v187, v47, v43, s11
    v_perm_b32 v188, v23, v19, s12
    v_perm_b32 v189, v31, v27, s12
    v_perm_b32 v190, v39, v35, s12
    v_perm_b32 v191, v47, v43, s12
    v_mfma_f32_16x16x32_bf16 v[192:195], v[160:163], v[144:147], 0
    v_mfma_f32_16x16x32_bf16 v[196:199], v[164:167], v[144:147], 0
    v_mfma_f32_16x16x32_bf16 v[200:203], v[168:171], v[144:147], 0
    v_mfma_f32_16x16x32_bf16 v[204:207], v[172:175], v[144:147], 0
    v_mfma_f32_16x16x32_bf16 v[208:211], v[176:179], v[144:147], 0
    v_mfma_f32_16x16x32_bf16 v[212:215], v[180:183], v[144:147], 0
    v_mfma_f32_16x16x32_bf16 v[216:219], v[184:187], v[144:147], 0
    v_mfma_f32_16x16x32_bf16 v[220:223], v[188:191], v[144:147], 0
    s_waitcnt vmcnt(16)
    v_perm_b32 v160, v52, v48, s11
    v_perm_b32 v161, v60, v56, s11
    v_perm_b32 v162, v68, v64, s11
    v_perm_b32 v163, v76, v72, s11
    v_perm_b32 v164, v52, v48, s12
    v_perm_b32 v165, v60, v56, s12
    v_perm_b32 v166, v68, v64, s12
    v_perm_b32 v167, v76, v72, s12
    v_perm_b32 v168, v53, v49, s11
    v_perm_b32 v169, v61, v57, s11
    v_perm_b32 v170, v69, v65, s11
    v_perm_b32 v171, v77, v73, s11
    v_perm_b32 v172, v53, v49, s12
    v_perm_b32 v173, v61, v57, s12
    v_perm_b32 v174, v69, v65, s12
    v_perm_b32 v175, v77, v73, s12
    v_perm_b32 v176, v54, v50, s11
    v_perm_b32 v177, v62, v58, s11
    v_perm_b32 v178, v70, v66, s11
    v_perm_b32 v179, v78, v74, s11
    v_perm_b32 v180, v54, v50, s12
    v_perm_b32 v181, v62, v58, s12
    v_perm_b32 v182, v70, v66, s12
    v_perm_b32 v183, v78, v74, s12
    v_perm_b32 v184, v55, v51, s11
    v_perm_b32 v185, v63, v59, s11
    v_perm_b32 v186, v71, v67, s11
    v_perm_b32 v187, v79, v75, s11
    v_perm_b32 v188, v55, v51, s12
    v_perm_b32 v189, v63, v59, s12
    v_perm_b32 v190, v71, v67, s12
    v_perm_b32 v191, v79, v75, s12
    v_mfma_f32_16x16x32_bf16 v[192:195], v[160:163], v[148:151], v[192:195]
    v_mfma_f32_16x16x32_bf16 v[196:199], v[164:167], v[148:151], v[196:199]
    v_mfma_f32_16x16x32_bf16 v[200:203], v[168:171], v[148:151], v[200:203]
    v_mfma_f32_16x16x32_bf16 v[204:207], v[172:175], v[148:151], v[204:207]
    v_mfma_f32_16x16x32_bf16 v[208:211], v[176:179], v[148:151], v[208:211]
    v_mfma_f32_16x16x32_bf16 v[212:215], v[180:183], v[148:151], v[212:215]
    v_mfma_f32_16x16x32_bf16 v[216:219], v[184:187], v[148:151], v[216:219]
    v_mfma_f32_16x16x32_bf16 v[220:223], v[188:191], v[148:151], v[220:223]
    s_waitcnt vmcnt(8)
    v_perm_b32 v160, v84, v80, s11
    v_perm_b32 v161, v92, v88, s11
    v_perm_b32 v162, v100, v96, s11
    v_perm_b32 v163, v108, v104, s11
    v_perm_b32 v164, v84, v80, s12
    v_perm_b32 v165, v92, v88, s12
    v_perm_b32 v166, v100, v96, s12
    v_perm_b32 v167, v108, v104, s12
    v_perm_b32 v168, v85, v81, s11
    v_perm_b32 v169, v93, v89, s11
    v_perm_b32 v170, v101, v97, s11
    v_perm_b32 v171, v109, v105, s11
    v_perm_b32 v172, v85, v81, s12
    v_perm_b32 v173, v93, v89, s12
    v_perm_b32 v174, v101, v97, s12
    v_perm_b32 v175, v109, v105, s12
    v_perm_b32 v176, v86, v82, s11
    v_perm_b32 v177, v94, v90, s11
    v_perm_b32 v178, v102, v98, s11
    v_perm_b32 v179, v110, v106, s11
    v_perm_b32 v180, v86, v82, s12
    v_perm_b32 v181, v94, v90, s12
    v_perm_b32 v182, v102, v98, s12
    v_perm_b32 v183, v110, v106, s12
    v_perm_b32 v184, v87, v83, s11
    v_perm_b32 v185, v95, v91, s11
    v_perm_b32 v186, v103, v99, s11
    v_perm_b32 v187, v111, v107, s11
    v_perm_b32 v188, v87, v83, s12
    v_perm_b32 v189, v95, v91, s12
    v_perm_b32 v190, v103, v99, s12
    v_perm_b32 v191, v111, v107, s12
    v_mfma_f32_16x16x32_bf16 v[192:195], v[160:163], v[152:155], v[192:195]
    v_mfma_f32_16x16x32_bf16 v[196:199], v[164:167], v[152:155], v[196:199]
    v_mfma_f32_16x16x32_bf16 v[200:203], v[168:171], v[152:155], v[200:203]
    v_mfma_f32_16x16x32_bf16 v[204:207], v[172:175], v[152:155], v[204:207]
    v_mfma_f32_16x16x32_bf16 v[208:211], v[176:179], v[152:155], v[208:211]
    v_mfma_f32_16x16x32_bf16 v[212:215], v[180:183], v[152:155], v[212:215]
    v_mfma_f32_16x16x32_bf16 v[216:219], v[184:187], v[152:155], v[216:219]
    v_mfma_f32_16x16x32_bf16 v[220:223], v[188:191], v[152:155], v[220:223]
    ds_read_b32 v10, v1 offset:36
    s_waitcnt lgkmcnt(0)
    v_readfirstlane_b32 s93, v10
    s_nop 0
    s_cmp_ge_u32 s93, 4
    s_cbranch_scc0 L_B_fskip
    s_sub_u32 s14, s3, 0
    s_and_b32 s14, s14, 3
    s_lshl_b32 s14, s14, 6
    s_add_u32 s14, s14, 147520
    v_lshl_add_u32 v10, v4, 2, s14
    ds_read_b32 v148, v10
    s_sub_u32 s14, s3, 1
    s_and_b32 s14, s14, 3
    s_lshl_b32 s14, s14, 6
    s_add_u32 s14, s14, 147520
    v_lshl_add_u32 v10, v4, 2, s14
    ds_read_b32 v149, v10
    s_sub_u32 s14, s3, 2
    s_and_b32 s14, s14, 3
    s_lshl_b32 s14, s14, 6
    s_add_u32 s14, s14, 147520
    v_lshl_add_u32 v10, v4, 2, s14
    ds_read_b32 v150, v10
    s_sub_u32 s14, s3, 3
    s_and_b32 s14, s14, 3
    s_lshl_b32 s14, s14, 6
    s_add_u32 s14, s14, 147520
    v_lshl_add_u32 v10, v4, 2, s14
    ds_read_b32 v151, v10
L_B_fskip:
    v_lshrrev_b32 v12, 2, v4
    v_lshlrev_b32 v12, 10, v12
    v_and_b32 v10, 3, v4
    v_lshl_add_u32 v12, v10, 6, v12
    v_lshl_add_u32 v12, v3, 4, v12
    s_lshl_b32 s43, s41, 12
    s_lshl_b32 s14, s3, 8
    s_add_u32 s43, s43, s14
    s_add_u32 s43, s43, 3145728
    s_lshl_b32 s44, s41, 4
    s_lshl_b32 s14, s3, 2
    s_add_u32 s44, s44, s14
    s_add_u32 s44, s44, 36864
    v_lshlrev_b32 v9, 2, v2
    s_add_u32 s14, s3, 1
    s_and_b32 s14, s14, 3
    s_lshl_b32 s14, s14, 13
    s_add_u32 s14, s14, 0
    v_add_u32 v13, s14, v9
    s_add_u32 s14, s3, 2
    s_and_b32 s14, s14, 3
    s_lshl_b32 s14, s14, 13
    s_add_u32 s14, s14, 2048
    v_add_u32 v14, s14, v9
    s_add_u32 s14, s3, 3
    s_and_b32 s14, s14, 3
    s_lshl_b32 s14, s14, 13
    s_add_u32 s14, s14, 4096
    v_add_u32 v15, s14, v9
    s_lshl_b32 s14, s3, 13
    s_add_u32 s14, s14, 0
    v_add_u32 v7, s14, v9
    s_waitcnt vmcnt(6)
    v_perm_b32 v160, v116, v112, s11
    v_perm_b32 v164, v116, v112, s12
    v_perm_b32 v168, v117, v113, s11
    v_perm_b32 v172, v117, v113, s12
    v_perm_b32 v176, v118, v114, s11
    v_perm_b32 v180, v118, v114, s12
    v_perm_b32 v184, v119, v115, s11
    v_perm_b32 v188, v119, v115, s12
    s_waitcnt vmcnt(4)
    v_perm_b32 v161, v124, v120, s11
    v_perm_b32 v165, v124, v120, s12
    v_perm_b32 v169, v125, v121, s11
    v_perm_b32 v173, v125, v121, s12
    v_perm_b32 v177, v126, v122, s11
    v_perm_b32 v181, v126, v122, s12
    v_perm_b32 v185, v127, v123, s11
    v_perm_b32 v189, v127, v123, s12
    s_waitcnt vmcnt(2)
    v_perm_b32 v162, v132, v128, s11
    v_perm_b32 v166, v132, v128, s12
    v_perm_b32 v170, v133, v129, s11
    v_perm_b32 v174, v133, v129, s12
    v_perm_b32 v178, v134, v130, s11
    v_perm_b32 v182, v134, v130, s12
    v_perm_b32 v186, v135, v131, s11
    v_perm_b32 v190, v135, v131, s12
    s_waitcnt vmcnt(0)
    v_perm_b32 v163, v140, v136, s11
    v_perm_b32 v167, v140, v136, s12
    v_perm_b32 v171, v141, v137, s11
    v_perm_b32 v175, v141, v137, s12
    v_perm_b32 v179, v142, v138, s11
    v_perm_b32 v183, v142, v138, s12
    v_perm_b32 v187, v143, v139, s11
    v_perm_b32 v191, v143, v139, s12
    v_mfma_f32_16x16x32_bf16 v[192:195], v[160:163], v[156:159], v[192:195]
    v_mfma_f32_16x16x32_bf16 v[196:199], v[164:167], v[156:159], v[196:199]
    v_mfma_f32_16x16x32_bf16 v[200:203], v[168:171], v[156:159], v[200:203]
    v_mfma_f32_16x16x32_bf16 v[204:207], v[172:175], v[156:159], v[204:207]
    v_mfma_f32_16x16x32_bf16 v[208:211], v[176:179], v[156:159], v[208:211]
    v_mfma_f32_16x16x32_bf16 v[212:215], v[180:183], v[156:159], v[212:215]
    v_mfma_f32_16x16x32_bf16 v[216:219], v[184:187], v[156:159], v[216:219]
    v_mfma_f32_16x16x32_bf16 v[220:223], v[188:191], v[156:159], v[220:223]
    s_cmp_ge_u32 s93, 4
    s_cbranch_scc1 L_B_fdone
    s_mov_b32 s15, 0
Lw71:
    ds_read_b32 v10, v1 offset:36
    s_add_u32 s15, s15, 1
    s_waitcnt lgkmcnt(0)
    v_readfirstlane_b32 s14, v10
    s_cmp_gt_u32 s15, 480000
    s_cbranch_scc1 Lw71_o
    s_cmp_ge_u32 s14, 4
    s_cbranch_scc0 Lw71
Lw71_o:
    s_sub_u32 s14, s3, 0
    s_and_b32 s14, s14, 3
    s_lshl_b32 s14, s14, 6
    s_add_u32 s14, s14, 147520
    v_lshl_add_u32 v10, v4, 2, s14
    ds_read_b32 v148, v10
    s_sub_u32 s14, s3, 1
    s_and_b32 s14, s14, 3
    s_lshl_b32 s14, s14, 6
    s_add_u32 s14, s14, 147520
    v_lshl_add_u32 v10, v4, 2, s14
    ds_read_b32 v149, v10
    s_sub_u32 s14, s3, 2
    s_and_b32 s14, s14, 3
    s_lshl_b32 s14, s14, 6
    s_add_u32 s14, s14, 147520
    v_lshl_add_u32 v10, v4, 2, s14
    ds_read_b32 v150, v10
    s_sub_u32 s14, s3, 3
    s_and_b32 s14, s14, 3
    s_lshl_b32 s14, s14, 6
    s_add_u32 s14, s14, 147520
    v_lshl_add_u32 v10, v4, 2, s14
    ds_read_b32 v151, v10
L_B_fdone:
    ds_write2st64_b32 v13, v193, v197 offset0:0 offset1:1
    ds_write2st64_b32 v13, v201, v205 offset0:2 offset1:3
    ds_write2st64_b32 v13, v209, v213 offset0:4 offset1:5
    ds_write2st64_b32 v13, v217, v221 offset0:6 offset1:7
    ds_write2st64_b32 v14, v194, v198 offset0:0 offset1:1
    ds_write2st64_b32 v14, v202, v206 offset0:2 offset1:3
    ds_write2st64_b32 v14, v210, v214 offset0:4 offset1:5
    ds_write2st64_b32 v14, v218, v222 offset0:6 offset1:7
    ds_write2st64_b32 v15, v195, v199 offset0:0 offset1:1
    ds_write2st64_b32 v15, v203, v207 offset0:2 offset1:3
    ds_write2st64_b32 v15, v211, v215 offset0:4 offset1:5
    ds_write2st64_b32 v15, v219, v223 offset0:6 offset1:7
    s_waitcnt lgkmcnt(0)
    s_mov_b64 exec, 1
    ds_add_u32 v1, v6 offset:12
    s_mov_b64 exec, -1
    s_mov_b32 s15, 0
Lw72:
    ds_read_b32 v10, v1 offset:12
    s_add_u32 s15, s15, 1
    s_waitcnt lgkmcnt(0)
    v_readfirstlane_b32 s14, v10
    s_cmp_gt_u32 s15, 480000
    s_cbranch_scc1 Lw72_o
    s_cmp_ge_u32 s14, 4
    s_cbranch_scc0 Lw72
Lw72_o:
    ds_read2st64_b32 v[16:17], v7 offset0:0 offset1:1
    ds_read2st64_b32 v[18:19], v7 offset0:2 offset1:3
    ds_read2st64_b32 v[20:21], v7 offset0:4 offset1:5
    ds_read2st64_b32 v[22:23], v7 offset0:6 offset1:7
    ds_read2st64_b32 v[24:25], v7 offset0:8 offset1:9
    ds_read2st64_b32 v[26:27], v7 offset0:10 offset1:11
    ds_read2st64_b32 v[28:29], v7 offset0:12 offset1:13
    ds_read2st64_b32 v[30:31], v7 offset0:14 offset1:15
    ds_read2st64_b32 v[32:33], v7 offset0:16 offset1:17
    ds_read2st64_b32 v[34:35], v7 offset0:18 offset1:19
    ds_read2st64_b32 v[36:37], v7 offset0:20 offset1:21
    ds_read2st64_b32 v[38:39], v7 offset0:22 offset1:23
    v_mul_f32 v192, v192, v148
    v_mul_f32 v196, v196, v148
    v_mul_f32 v200, v200, v148
    v_mul_f32 v204, v204, v148
    v_mul_f32 v208, v208, v148
    v_mul_f32 v212, v212, v148
    v_mul_f32 v216, v216, v148
    v_mul_f32 v220, v220, v148
    s_waitcnt lgkmcnt(8)
    v_fmac_f32 v192, v16, v149
    v_fmac_f32 v196, v17, v149
    v_fmac_f32 v200, v18, v149
    v_fmac_f32 v204, v19, v149
    v_fmac_f32 v208, v20, v149
    v_fmac_f32 v212, v21, v149
    v_fmac_f32 v216, v22, v149
    v_fmac_f32 v220, v23, v149
    s_waitcnt lgkmcnt(4)
    v_fmac_f32 v192, v24, v150
    v_fmac_f32 v196, v25, v150
    v_fmac_f32 v200, v26, v150
    v_fmac_f32 v204, v27, v150
    v_fmac_f32 v208, v28, v150
    v_fmac_f32 v212, v29, v150
    v_fmac_f32 v216, v30, v150
    v_fmac_f32 v220, v31, v150
    s_waitcnt lgkmcnt(0)
    v_fmac_f32 v192, v32, v151
    v_fmac_f32 v196, v33, v151
    v_fmac_f32 v200, v34, v151
    v_fmac_f32 v204, v35, v151
    v_fmac_f32 v208, v36, v151
    v_fmac_f32 v212, v37, v151
    v_fmac_f32 v216, v38, v151
    v_fmac_f32 v220, v39, v151
    v_cvt_pk_bf16_f32 v48, v192, v196
    v_cvt_pk_bf16_f32 v49, v200, v204
    v_cvt_pk_bf16_f32 v50, v208, v212
    v_cvt_pk_bf16_f32 v51, v216, v220
    s_cmp_eq_u32 s58, 1
    s_cbranch_scc1 Ls73_f
    buffer_store_dwordx4 v[48:51], v12, s[32:35], s43 offen sc1
    s_branch Ls73_d
Ls73_f:
    buffer_store_dwordx4 v[48:51], v12, s[32:35], s43 offen
Ls73_d:
    s_mov_b64 exec, 1
    s_cmp_eq_u32 s58, 1
    s_cbranch_scc1 Ls74_f
    buffer_store_dword v8, v5, s[32:35], s44 offen sc1
    s_branch Ls74_d
Ls74_f:
    buffer_store_dword v8, v5, s[32:35], s44 offen
Ls74_d:
    s_mov_b64 exec, -1
    s_cmp_lg_u32 s3, 0
    s_cbranch_scc1 L_end
    v_lshrrev_b32 v9, 5, v2
    v_lshlrev_b32 v9, 19, v9
    v_and_b32 v10, 1, v3
    v_lshl_add_u32 v9, v10, 8, v9
    v_lshl_add_u32 v9, v4, 4, v9
    s_lshl_b32 s43, s5, 12
    s_lshl_b32 s14, s4, 9
    s_add_u32 s43, s43, s14
    s_add_u32 s43, s43, 5242880
    s_mov_b32 s36, s26
    s_mov_b32 s37, s27
    s_mov_b32 s38, 65536
    s_mov_b32 s39, 0x20000
    v_and_b32 v10, 1, v3
    v_lshlrev_b32 v13, 10, v10
    v_lshl_add_u32 v13, v4, 3, v13
    s_lshl_b32 s46, s6, 14
    s_lshl_b32 s14, s4, 11
    s_add_u32 s46, s46, s14
    s_lshl_b32 s14, s59, 7
    s_add_u32 s46, s46, s14
    s_barrier
    s_mov_b32 s14, 0x0c0c0400
    s_mov_b32 s15, 0x04000c0c
    s_add_u32 s48, s43, 0
    s_add_u32 s49, s43, 131072
    s_add_u32 s50, s43, 262144
    s_add_u32 s51, s43, 393216
    s_mov_b32 s45, 0
    buffer_load_dwordx4 v[16:19], v9, s[32:35], s48 offen sc1
    buffer_load_dwordx4 v[20:23], v9, s[32:35], s49 offen sc1
    buffer_load_dwordx4 v[24:27], v9, s[32:35], s50 offen sc1
    buffer_load_dwordx4 v[28:31], v9, s[32:35], s51 offen sc1
L_B_pretry:
    s_waitcnt vmcnt(0)
    v_perm_b32 v10, v17, v16, s14
    v_perm_b32 v12, v19, v18, s15
    v_or_b32 v10, v10, v12
    v_xor_b32 v10, v10, v8
    v_perm_b32 v11, v21, v20, s14
    v_perm_b32 v12, v23, v22, s15
    v_or_b32 v11, v11, v12
    v_xor_b32 v11, v11, v8
    v_or_b32 v10, v10, v11
    v_perm_b32 v11, v25, v24, s14
    v_perm_b32 v12, v27, v26, s15
    v_or_b32 v11, v11, v12
    v_xor_b32 v11, v11, v8
    v_or_b32 v10, v10, v11
    v_perm_b32 v11, v29, v28, s14
    v_perm_b32 v12, v31, v30, s15
    v_or_b32 v11, v11, v12
    v_xor_b32 v11, v11, v8
    v_or_b32 v10, v10, v11
    v_cmp_ne_u32 vcc, 0, v10
    s_cbranch_vccz L_B_pok0
    buffer_load_dwordx4 v[16:19], v9, s[32:35], s48 offen sc1
    buffer_load_dwordx4 v[20:23], v9, s[32:35], s49 offen sc1
    buffer_load_dwordx4 v[24:27], v9, s[32:35], s50 offen sc1
    buffer_load_dwordx4 v[28:31], v9, s[32:35], s51 offen sc1
    s_add_u32 s45, s45, 1
    s_cmp_le_u32 s45, 30000
    s_cbranch_scc1 L_B_pretry
    s_waitcnt vmcnt(0)
L_B_pok0:
    v_add_f32 v80, v16, v20
    v_add_f32 v84, v24, v28
    v_add_f32 v81, v17, v21
    v_add_f32 v85, v25, v29
    v_add_f32 v82, v18, v22
    v_add_f32 v86, v26, v30
    v_add_f32 v83, v19, v23
    v_add_f32 v87, v27, v31
L_B_psum:
    v_add_f32 v80, v80, v84
    v_add_f32 v81, v81, v85
    v_add_f32 v82, v82, v86
    v_add_f32 v83, v83, v87
    v_mov_b32 v84, v80
    v_mov_b32 v85, v81
    v_mov_b32 v86, v82
    v_mov_b32 v87, v83
    v_permlane32_swap_b32 v80, v84
    v_permlane32_swap_b32 v81, v85
    v_permlane32_swap_b32 v82, v86
    v_permlane32_swap_b32 v83, v87
    v_add_f32 v80, v80, v84
    v_add_f32 v81, v81, v85
    v_add_f32 v82, v82, v86
    v_add_f32 v83, v83, v87
    v_cvt_pk_bf16_f32 v88, v80, v81
    v_cvt_pk_bf16_f32 v89, v82, v83
    s_mov_b32 exec_hi, 0
    buffer_store_dwordx2 v[88:89], v13, s[36:39], s46 offen
    s_or_b32 s14, s4, s7
    s_cmp_lg_u32 s14, 0
    s_cbranch_scc1 L_B_fin
    s_mov_b64 exec, 1
    s_lshl_b32 s14, s6, 7
    buffer_store_dword v8, v5, s[32:35], s14 offen sc1
L_B_fin:
    s_mov_b64 exec, -1
L_end:
    s_endpgm
.section .rodata,"a"
.p2align 6
.amdhsa_kernel standalone__sliding_block_cached__sampling_kernel
  .amdhsa_next_free_vgpr 256
  .amdhsa_next_free_sgpr 102
  .amdhsa_accum_offset 256
  .amdhsa_group_segment_fixed_size 0
  .amdhsa_kernarg_size 64
  .amdhsa_user_sgpr_count 2
  .amdhsa_user_sgpr_kernarg_segment_ptr 1
  .amdhsa_system_sgpr_workgroup_id_x 1
.end_amdhsa_kernel
```
